```python
import torch

def _softmax(x, axis=-1):
    return torch.softmax(x, dim=axis)
def _gelu(x):
    return torch.nn.functional.gelu(x, approximate="tanh")
def _silu(x):
    return torch.nn.functional.silu(x)
def _sigmoid(x):
    return torch.sigmoid(x)
def _layernorm(x, axis=-1, eps=1e-5):
    m = x.mean(dim=axis, keepdim=True)
    v = x.var(dim=axis, keepdim=True, unbiased=False)
    return (x - m) / torch.sqrt(v + eps)
def _scatter_add(tgt, idx, src, axis=0):
    return tgt.clone().index_add_(axis, idx, src)
def _segment_sum(src, seg, n):
    out = torch.zeros((n,) + src.shape[1:], dtype=src.dtype)
    return out.index_add_(0, seg, src)
def _pad(x, pw):
    flat = tuple(v for pair in reversed(pw) for v in pair)
    return torch.nn.functional.pad(x, flat)

kernel_name = 'sequential_preLN__sliding_block_cached__dense_activation_silu__decode'

def setup_inputs():

    _w = (lambda a: (lambda t: t.to(torch.bfloat16) if t.is_floating_point() else t)(torch.as_tensor(a)))
    def _A_setup():
        B, Sq, D = 4, 1, 512
        Hq, Hkv, Sk, Dh = 32, 8, 16384, 128
        assert Hq % Hkv == 0, (Hq, Hkv)
        return {
            "x": _w((lambda *s: torch.randn(*s, dtype=torch.bfloat16) * 0.05)(B, Sq, D)),
            "k_cache": _w((lambda *s: torch.randn(*s, dtype=torch.bfloat16) * 3.2)(B, Hkv, Sk, Dh)),
            "v_cache": _w((lambda *s: torch.randn(*s, dtype=torch.bfloat16) * 0.8)(B, Hkv, Sk, Dh)),
            "wq": _w((lambda *s: torch.randn(*s, dtype=torch.bfloat16) * 3.2)(D, Hq * Dh) * (D ** -0.5)),
            "wo": _w((lambda *s: torch.randn(*s, dtype=torch.bfloat16) * 0.8)(Hq * Dh, D) * ((Hq * Dh) ** -0.5)),
        }
    _A_in = _A_setup()

    def _B_setup():
        B, S, D, F = 4, 1, 512, 1792
        return {
            "x": _w((lambda *s: torch.randn(*s, dtype=torch.bfloat16) * 0.05)(B, S, D)),
            "w1": _w((lambda *s: torch.randn(*s, dtype=torch.bfloat16) * 3.2)(D, F) * (D ** -0.5)),
            "w2": _w((lambda *s: torch.randn(*s, dtype=torch.bfloat16) * 0.8)(F, D) * (F ** -0.5)),
        }
    _B_in = _B_setup()

    return {
        "A_x": _A_in["x"],
        "A_k_cache": _A_in["k_cache"],
        "A_v_cache": _A_in["v_cache"],
        "A_wq": _A_in["wq"],
        "A_wo": _A_in["wo"],
        "B_x": _B_in["x"],
        "B_w1": _B_in["w1"],
        "B_w2": _B_in["w2"],
    }

def reference(A_x, A_k_cache, A_v_cache, A_wq, A_wo, B_x, B_w1, B_w2):
    def _A_ref(x, k_cache, v_cache, wq, wo):
        B, Sq, D = x.shape
        Hq, Dh = 32, 128
        Hkv, Sk = k_cache.shape[1], k_cache.shape[2]
        W = min(4096, max(256, Sk // 4))
        rep = Hq // Hkv
        q = (lambda x, *d: x.permute(*d))((x @ wq).reshape(B, Sq, Hq, Dh), 0, 2, 1, 3)
        k = (lambda x, n, axis: torch.repeat_interleave(x, n, dim=axis))(k_cache[:, :, Sk - W:, :], rep, axis=1)
        v = (lambda x, n, axis: torch.repeat_interleave(x, n, dim=axis))(v_cache[:, :, Sk - W:, :], rep, axis=1)
        scores = torch.einsum("bhqd,bhkd->bhqk", q, k) * (Dh ** -0.5)
        p = _softmax(scores, axis=-1)
        o = torch.einsum("bhqk,bhkd->bhqd", p, v)
        return (lambda x, *d: x.permute(*d))(o, 0, 2, 1, 3).reshape(B, Sq, Hq * Dh) @ wo

    def _B_ref(x, w1, w2):
        h = torch.einsum("bsd,df->bsf", x, w1)
        h = _silu(h)
        out = torch.einsum("bsf,fd->bsd", h, w2)
        return out

    x = A_x
    h = x + _A_ref(_layernorm(x, axis=-1), A_k_cache, A_v_cache, A_wq, A_wo)
    h2 = h + _B_ref(_layernorm(h, axis=-1), B_w1, B_w2)
    return h2
```

```asm
; @launch grid=(256,1,1) block=(512,1,1) lds=159232
.amdgcn_target "amdgcn-amd-amdhsa--gfx950"
.text
.globl sequential_preLN__sliding_block_cached__dense_activation_silu__decode_kernel
.p2align 8
.type sequential_preLN__sliding_block_cached__dense_activation_silu__decode_kernel,@function
sequential_preLN__sliding_block_cached__dense_activation_silu__decode_kernel:
    s_cmp_ge_u32 s2, 256
    s_cbranch_scc1 L_end
    s_load_dwordx16 s[4:19], s[0:1], 0
    s_load_dwordx4 s[20:23], s[0:1], 64
    s_load_dwordx2 s[24:25], s[0:1], 80
    v_lshrrev_b32 v1, 6, v0
    v_and_b32 v0, 63, v0
    v_readfirstlane_b32 s3, v1
    s_lshr_b32 s27, s2, 3
    s_and_b32 s26, s2, 7
    s_and_b32 s29, s27, 7
    s_lshr_b32 s28, s27, 3
    v_lshrrev_b32 v6, 4, v0
    v_and_b32 v7, 15, v0
    s_and_b32 s30, s3, 3
    s_lshl3_add_u32 s63, s28, s26
    s_lshl_b32 s64, s63, 22
    s_add_u32 s64, s64, 0x300000
    s_lshl2_add_u32 s65, s29, s30
    s_lshl_b32 s65, s65, 12
    s_mov_b32 s34, 0x100000
    s_mov_b32 s35, 0x20000
    v_mov_b32 v20, 151808
    v_lshl_add_u32 v2, v0, 2, v20
    v_mov_b32 v22, 0
    ds_write_b32 v2, v22
    v_xor_b32 v9, v7, v6
    v_lshlrev_b32 v9, 4, v9
    v_lshl_add_u32 v2, v6, 8, v9
    v_xor_b32 v3, 64, v2
    v_xor_b32 v4, 0x80, v2
    v_xor_b32 v5, 0xc0, v2
    s_lshl_b32 s67, s30, 15
    s_mov_b32 m0, s67
    s_cmp_ge_u32 s3, 4
    s_waitcnt lgkmcnt(0)
    s_barrier
    s_cbranch_scc1 L_vwave
    s_add_u32 s32, s6, s64
    s_addc_u32 s33, s7, 0
    s_and_b32 s33, s33, 0xffff
    buffer_load_dwordx4 v2, s[32:35], s65 offen offset:0 nt lds
    buffer_load_dwordx4 v3, s[32:35], s65 offen offset:1024 nt lds
    buffer_load_dwordx4 v4, s[32:35], s65 offen offset:2048 nt lds
    buffer_load_dwordx4 v5, s[32:35], s65 offen offset:3072 nt lds
    s_add_u32 m0, m0, 4096
    s_add_u32 s65, s65, 131072
    buffer_load_dwordx4 v2, s[32:35], s65 offen offset:0 nt lds
    buffer_load_dwordx4 v3, s[32:35], s65 offen offset:1024 nt lds
    s_waitcnt vmcnt(5)
    buffer_load_dwordx4 v4, s[32:35], s65 offen offset:2048 nt lds
    s_branch L_k2
L_vwave:
    s_setprio 3
    v_lshlrev_b32 v1, 4, v0
    s_mul_i32 s77, s26, 7
    s_add_u32 s77, s77, s29
    s_lshl_b32 s66, s30, 2
    v_add_u32 v21, s66, v20
    v_mov_b32 v19, 1
    s_mov_b32 s50, 0x1c0000
    s_mov_b32 s51, 0x20000
    s_mov_b32 s39, 0x20000
    s_mov_b32 s38, 0x400000
    s_cmp_lt_u32 s3, 6
    s_cbranch_scc1 L_npf1
    s_cmp_lg_u32 s29, 3
    s_cbranch_scc1 L_npf1
    s_getpc_b64 s[68:69]
L_pc:
    s_sub_u32 s68, s68, L_pc-sequential_preLN__sliding_block_cached__dense_activation_silu__decode_kernel
    s_subb_u32 s69, s69, 0
    s_and_b32 s70, s3, 1
    s_lshl1_add_u32 s70, s28, s70
    s_lshl_b32 s70, s70, 10
L_pfl:
    v_add_u32 v2, s70, v1
    global_load_dwordx4 v[60:63], v2, s[68:69]
    s_add_u32 s70, s70, 8192
    s_cmp_lt_u32 s70, L_codeend-sequential_preLN__sliding_block_cached__dense_activation_silu__decode_kernel
    s_cbranch_scc1 L_pfl
L_npf1:
    s_add_u32 s75, s29, 4
    s_and_b32 s75, s75, 7
    v_lshrrev_b32 v10, 3, v0
    v_and_b32 v11, 7, v0
    v_and_b32 v12, 2, v10
    v_xor_b32 v11, v11, v12
    v_lshlrev_b32 v11, 4, v11
    v_lshl_add_u32 v2, v10, 13, v11
    v_xor_b32 v3, 64, v2
    s_lshl_b32 s69, s28, 20
    s_lshl_b32 s76, s26, 10
    s_add_u32 s69, s69, s76
    s_lshl_b32 s76, s75, 7
    s_add_u32 s69, s69, s76
    s_lshl_b32 s76, s30, 18
    s_add_u32 s69, s69, s76
    s_lshl_b32 s76, s30, 12
    s_add_u32 m0, s76, 131072
    v_lshlrev_b32 v12, 4, v7
    v_lshl_add_u32 v12, v6, 10, v12
    s_lshl_b32 s76, s28, 8
    v_add_u32 v12, s76, v12
    v_xor_b32 v13, 0x100, v12
    v_xor_b32 v14, 0x200, v12
    v_xor_b32 v15, 0x300, v12
    s_waitcnt lgkmcnt(0)
    s_mov_b32 s36, s10
    s_and_b32 s37, s11, 0xffff
    s_cmp_lg_u32 s3, 4
    s_cbranch_scc1 L_wq2
    global_load_dwordx4 v[64:67], v12, s[4:5]
    global_load_dwordx4 v[68:71], v13, s[4:5]
    global_load_dwordx4 v[72:75], v14, s[4:5]
    global_load_dwordx4 v[76:79], v15, s[4:5]
    global_load_dwordx2 v[8:9], v22, s[24:25] sc1
L_wq2:
    buffer_load_dwordx4 v2, s[36:39], s69 offen nt lds
    s_add_u32 m0, m0, 1024
    s_add_u32 s69, s69, 0x10000
    buffer_load_dwordx4 v3, s[36:39], s69 offen nt lds
    s_add_u32 m0, m0, 1024
    s_add_u32 s69, s69, 0x10000
    buffer_load_dwordx4 v2, s[36:39], s69 offen nt lds
    s_add_u32 m0, m0, 1024
    s_add_u32 s69, s69, 0x10000
    buffer_load_dwordx4 v3, s[36:39], s69 offen nt lds
    s_branch L_vstart2
L_k2:
    v_lshlrev_b32 v1, 4, v0
    s_mul_i32 s77, s26, 7
    s_add_u32 s77, s77, s29
    s_lshl_b32 s66, s30, 2
    v_add_u32 v21, s66, v20
    v_mov_b32 v19, 1
    s_mov_b32 s50, 0x1c0000
    s_mov_b32 s51, 0x20000
    s_mov_b32 s39, 0x20000
    s_mov_b32 s38, 0x400000
    v_lshl_add_u32 v8, v7, 8, v9
    v_add_u32 v8, s67, v8
    v_lshrrev_b32 v10, 3, v0
    v_and_b32 v11, 7, v0
    v_and_b32 v12, 2, v10
    v_xor_b32 v11, v11, v12
    v_lshlrev_b32 v11, 4, v11
    v_lshl_add_u32 v16, v10, 10, v11
    v_xor_b32 v17, 64, v16
    s_lshl_b32 s72, s26, 19
    s_lshl_b32 s76, s30, 17
    s_add_u32 s72, s72, s76
    s_lshl_b32 s76, s29, 7
    s_add_u32 s72, s72, s76
    s_mov_b32 s36, s12
    s_and_b32 s37, s13, 0xffff
    s_waitcnt vmcnt(5)
    buffer_load_dwordx4 v5, s[32:35], s65 offen offset:3072 nt lds
    s_waitcnt vmcnt(5)
    s_add_u32 m0, m0, 4096
    s_add_u32 s65, s65, 131072
    buffer_load_dwordx4 v2, s[32:35], s65 offen offset:0 nt lds
    s_waitcnt vmcnt(5)
    buffer_load_dwordx4 v[128:131], v16, s[36:39], s72 offen
    s_add_u32 s72, s72, 8192
    s_waitcnt vmcnt(5)
    buffer_load_dwordx4 v3, s[32:35], s65 offen offset:1024 nt lds
    s_waitcnt vmcnt(5)
    buffer_load_dwordx4 v4, s[32:35], s65 offen offset:2048 nt lds
    s_waitcnt vmcnt(5)
    buffer_load_dwordx4 v[132:135], v17, s[36:39], s72 offen
    s_add_u32 s72, s72, 8192
    s_waitcnt vmcnt(5)
    buffer_load_dwordx4 v5, s[32:35], s65 offen offset:3072 nt lds
    s_waitcnt vmcnt(5)
    s_add_u32 m0, m0, 4096
    s_add_u32 s65, s65, 131072
    buffer_load_dwordx4 v2, s[32:35], s65 offen offset:0 nt lds
    s_waitcnt vmcnt(5)
    buffer_load_dwordx4 v3, s[32:35], s65 offen offset:1024 nt lds
    s_waitcnt vmcnt(5)
    buffer_load_dwordx4 v[136:139], v16, s[36:39], s72 offen
    s_add_u32 s72, s72, 8192
    s_waitcnt vmcnt(5)
    buffer_load_dwordx4 v4, s[32:35], s65 offen offset:2048 nt lds
    s_waitcnt vmcnt(5)
    buffer_load_dwordx4 v5, s[32:35], s65 offen offset:3072 nt lds
    s_waitcnt vmcnt(5)
    s_add_u32 m0, m0, 4096
    s_add_u32 s65, s65, 131072
    buffer_load_dwordx4 v2, s[32:35], s65 offen offset:0 nt lds
    s_waitcnt vmcnt(5)
    buffer_load_dwordx4 v[140:143], v17, s[36:39], s72 offen
    s_add_u32 s72, s72, 8192
    s_waitcnt vmcnt(5)
    buffer_load_dwordx4 v3, s[32:35], s65 offen offset:1024 nt lds
    s_waitcnt vmcnt(5)
    buffer_load_dwordx4 v4, s[32:35], s65 offen offset:2048 nt lds
    s_waitcnt vmcnt(5)
    buffer_load_dwordx4 v5, s[32:35], s65 offen offset:3072 nt lds
    s_waitcnt vmcnt(5)
    buffer_load_dwordx4 v[144:147], v16, s[36:39], s72 offen
    s_add_u32 s72, s72, 8192
    s_waitcnt vmcnt(5)
    s_add_u32 m0, m0, 4096
    s_add_u32 s65, s65, 131072
    buffer_load_dwordx4 v2, s[32:35], s65 offen offset:0 nt lds
    s_waitcnt vmcnt(5)
    buffer_load_dwordx4 v3, s[32:35], s65 offen offset:1024 nt lds
    s_waitcnt vmcnt(5)
    buffer_load_dwordx4 v4, s[32:35], s65 offen offset:2048 nt lds
    s_waitcnt vmcnt(5)
    buffer_load_dwordx4 v[148:151], v17, s[36:39], s72 offen
    s_add_u32 s72, s72, 8192
    s_waitcnt vmcnt(5)
    buffer_load_dwordx4 v5, s[32:35], s65 offen offset:3072 nt lds
    s_waitcnt vmcnt(5)
    s_add_u32 m0, m0, 4096
    s_add_u32 s65, s65, 131072
    buffer_load_dwordx4 v2, s[32:35], s65 offen offset:0 nt lds
    s_waitcnt vmcnt(5)
    buffer_load_dwordx4 v3, s[32:35], s65 offen offset:1024 nt lds
    s_waitcnt vmcnt(5)
    buffer_load_dwordx4 v[152:155], v16, s[36:39], s72 offen
    s_add_u32 s72, s72, 8192
    s_waitcnt vmcnt(5)
    buffer_load_dwordx4 v4, s[32:35], s65 offen offset:2048 nt lds
    s_waitcnt vmcnt(5)
    buffer_load_dwordx4 v5, s[32:35], s65 offen offset:3072 nt lds
    s_waitcnt vmcnt(5)
    s_add_u32 m0, m0, 4096
    s_add_u32 s65, s65, 131072
    buffer_load_dwordx4 v2, s[32:35], s65 offen offset:0 nt lds
    s_waitcnt vmcnt(5)
    buffer_load_dwordx4 v[156:159], v17, s[36:39], s72 offen
    s_add_u32 s72, s72, 8192
    s_waitcnt vmcnt(5)
    buffer_load_dwordx4 v3, s[32:35], s65 offen offset:1024 nt lds
    s_waitcnt vmcnt(5)
    buffer_load_dwordx4 v4, s[32:35], s65 offen offset:2048 nt lds
    s_waitcnt vmcnt(5)
    buffer_load_dwordx4 v5, s[32:35], s65 offen offset:3072 nt lds
    s_waitcnt vmcnt(5)
    s_mov_b32 exec_lo, 0x1
    s_mov_b32 exec_hi, 0x0
    ds_add_u32 v20, v19 offset:16
    s_mov_b64 exec, -1
    s_setprio 2
    s_mov_b32 s48, s24
    s_and_b32 s49, s25, 0xffff
    v_xor_b32 v9, 64, v8
    v_xor_b32 v10, 0x80, v8
    v_xor_b32 v11, 0xc0, v8
    v_and_b32 v13, 1, v6
    v_lshlrev_b32 v12, 1, v13
    v_lshrrev_b32 v14, 1, v6
    v_or_b32 v12, v12, v14
    v_lshl_add_u32 v13, v7, 2, v12
    s_lshl_b32 s69, s30, 7
    v_add_u32 v14, s69, v13
    s_lshl_b32 s69, s28, 10
    v_lshl_add_u32 v15, v14, 1, s69
    global_load_ushort v22, v15, s[4:5]
    global_load_ushort v23, v15, s[4:5] offset:128
    global_load_ushort v28, v15, s[20:21]
    v_and_b32 v15, 3, v7
    v_mul_u32_u24 v15, 320, v15
    v_lshl_add_u32 v15, v6, 4, v15
    v_add_u32 v15, 148736, v15
    s_lshl_b32 s70, s63, 11
    s_add_u32 s70, s70, 0x10000
    s_mov_b32 s62, 0
L_lw3:
    ds_read_b32 v24, v20 offset:8
    s_add_u32 s62, s62, 1
    s_waitcnt lgkmcnt(0)
    v_readfirstlane_b32 s31, v24
    s_nop 0
    s_cmp_ge_u32 s31, 1
    s_cbranch_scc1 L_lwd4
    s_sleep 1
    s_cmp_lt_u32 s62, 800000
    s_cbranch_scc1 L_lw3
L_lwd4:
    ds_read_b64 v[26:27], v20 offset:56
    ds_read_b128 v[112:115], v15 offset:0
    ds_read_b128 v[116:119], v15 offset:64
    ds_read_b128 v[120:123], v15 offset:128
    ds_read_b128 v[124:127], v15 offset:192
    s_waitcnt vmcnt(39)
    ds_read_b128 v[32:35], v8 offset:0
    ds_read_b128 v[36:39], v9 offset:0
    ds_read_b128 v[40:43], v10 offset:0
    ds_read_b128 v[44:47], v11 offset:0
    s_waitcnt vmcnt(35)
    ds_read_b128 v[48:51], v8 offset:4096
    ds_read_b128 v[52:55], v9 offset:4096
    ds_read_b128 v[56:59], v10 offset:4096
    ds_read_b128 v[60:63], v11 offset:4096
    s_waitcnt vmcnt(29)
    ds_read_b128 v[64:67], v8 offset:8192
    ds_read_b128 v[68:71], v9 offset:8192
    ds_read_b128 v[72:75], v10 offset:8192
    ds_read_b128 v[76:79], v11 offset:8192
    s_waitcnt lgkmcnt(8)
    v_mfma_f32_16x16x32_bf16 v[80:83], v[112:115], v[32:35], 0
    v_mfma_f32_16x16x32_bf16 v[80:83], v[116:119], v[36:39], v[80:83]
    v_mfma_f32_16x16x32_bf16 v[80:83], v[120:123], v[40:43], v[80:83]
    v_mfma_f32_16x16x32_bf16 v[80:83], v[124:127], v[44:47], v[80:83]
    s_waitcnt vmcnt(24)
    ds_read_b128 v[32:35], v8 offset:12288
    ds_read_b128 v[36:39], v9 offset:12288
    ds_read_b128 v[40:43], v10 offset:12288
    ds_read_b128 v[44:47], v11 offset:12288
    s_waitcnt lgkmcnt(8)
    v_mfma_f32_16x16x32_bf16 v[84:87], v[112:115], v[48:51], 0
    v_mfma_f32_16x16x32_bf16 v[84:87], v[116:119], v[52:55], v[84:87]
    v_mfma_f32_16x16x32_bf16 v[84:87], v[120:123], v[56:59], v[84:87]
    v_mfma_f32_16x16x32_bf16 v[84:87], v[124:127], v[60:63], v[84:87]
    s_waitcnt vmcnt(19)
    ds_read_b128 v[48:51], v8 offset:16384
    ds_read_b128 v[52:55], v9 offset:16384
    ds_read_b128 v[56:59], v10 offset:16384
    ds_read_b128 v[60:63], v11 offset:16384
    s_waitcnt lgkmcnt(8)
    v_mfma_f32_16x16x32_bf16 v[88:91], v[112:115], v[64:67], 0
    v_mfma_f32_16x16x32_bf16 v[88:91], v[116:119], v[68:71], v[88:91]
    v_mfma_f32_16x16x32_bf16 v[88:91], v[120:123], v[72:75], v[88:91]
    v_mfma_f32_16x16x32_bf16 v[88:91], v[124:127], v[76:79], v[88:91]
    s_waitcnt vmcnt(13)
    ds_read_b128 v[64:67], v8 offset:20480
    ds_read_b128 v[68:71], v9 offset:20480
    ds_read_b128 v[72:75], v10 offset:20480
    ds_read_b128 v[76:79], v11 offset:20480
    s_waitcnt lgkmcnt(8)
    v_mfma_f32_16x16x32_bf16 v[92:95], v[112:115], v[32:35], 0
    v_mfma_f32_16x16x32_bf16 v[92:95], v[116:119], v[36:39], v[92:95]
    v_mfma_f32_16x16x32_bf16 v[92:95], v[120:123], v[40:43], v[92:95]
    v_mfma_f32_16x16x32_bf16 v[92:95], v[124:127], v[44:47], v[92:95]
    s_waitcnt vmcnt(8)
    ds_read_b128 v[32:35], v8 offset:24576
    ds_read_b128 v[36:39], v9 offset:24576
    ds_read_b128 v[40:43], v10 offset:24576
    ds_read_b128 v[44:47], v11 offset:24576
    s_waitcnt lgkmcnt(8)
    v_mfma_f32_16x16x32_bf16 v[96:99], v[112:115], v[48:51], 0
    v_mfma_f32_16x16x32_bf16 v[96:99], v[116:119], v[52:55], v[96:99]
    v_mfma_f32_16x16x32_bf16 v[96:99], v[120:123], v[56:59], v[96:99]
    v_mfma_f32_16x16x32_bf16 v[96:99], v[124:127], v[60:63], v[96:99]
    s_waitcnt vmcnt(3)
    ds_read_b128 v[48:51], v8 offset:28672
    ds_read_b128 v[52:55], v9 offset:28672
    ds_read_b128 v[56:59], v10 offset:28672
    ds_read_b128 v[60:63], v11 offset:28672
    s_waitcnt lgkmcnt(8)
    v_mfma_f32_16x16x32_bf16 v[100:103], v[112:115], v[64:67], 0
    v_mfma_f32_16x16x32_bf16 v[100:103], v[116:119], v[68:71], v[100:103]
    v_mfma_f32_16x16x32_bf16 v[100:103], v[120:123], v[72:75], v[100:103]
    v_mfma_f32_16x16x32_bf16 v[100:103], v[124:127], v[76:79], v[100:103]
    s_waitcnt lgkmcnt(4)
    v_mfma_f32_16x16x32_bf16 v[104:107], v[112:115], v[32:35], 0
    v_mfma_f32_16x16x32_bf16 v[104:107], v[116:119], v[36:39], v[104:107]
    v_mfma_f32_16x16x32_bf16 v[104:107], v[120:123], v[40:43], v[104:107]
    v_mfma_f32_16x16x32_bf16 v[104:107], v[124:127], v[44:47], v[104:107]
    s_waitcnt lgkmcnt(0)
    v_mfma_f32_16x16x32_bf16 v[108:111], v[112:115], v[48:51], 0
    v_mfma_f32_16x16x32_bf16 v[108:111], v[116:119], v[52:55], v[108:111]
    v_mfma_f32_16x16x32_bf16 v[108:111], v[120:123], v[56:59], v[108:111]
    v_mfma_f32_16x16x32_bf16 v[108:111], v[124:127], v[60:63], v[108:111]
    ds_write_b32 v21, v19 offset:80
    s_nop 4
    s_mov_b32 exec_lo, 0xffff
    s_mov_b32 exec_hi, 0x0
    v_cvt_pk_bf16_f32 v124, v80, v81
    v_cvt_pk_bf16_f32 v125, v82, v83
    v_cvt_pk_bf16_f32 v126, v96, v97
    v_cvt_pk_bf16_f32 v127, v98, v99
    s_mov_b32 exec_lo, 0xffff0000
    s_mov_b32 exec_hi, 0x0
    v_cvt_pk_bf16_f32 v124, v84, v85
    v_cvt_pk_bf16_f32 v125, v86, v87
    v_cvt_pk_bf16_f32 v126, v100, v101
    v_cvt_pk_bf16_f32 v127, v102, v103
    s_mov_b32 exec_lo, 0x0
    s_mov_b32 exec_hi, 0xffff
    v_cvt_pk_bf16_f32 v124, v88, v89
    v_cvt_pk_bf16_f32 v125, v90, v91
    v_cvt_pk_bf16_f32 v126, v104, v105
    v_cvt_pk_bf16_f32 v127, v106, v107
    s_mov_b32 exec_lo, 0x0
    s_mov_b32 exec_hi, 0xffff0000
    v_cvt_pk_bf16_f32 v124, v92, v93
    v_cvt_pk_bf16_f32 v125, v94, v95
    v_cvt_pk_bf16_f32 v126, v108, v109
    v_cvt_pk_bf16_f32 v127, v110, v111
    s_mov_b64 exec, -1
    s_mov_b32 s71, 0x3db504f3
    v_lshlrev_b32 v112, 16, v124
    v_and_b32 v113, 0xffff0000, v124
    v_lshlrev_b32 v114, 16, v125
    v_and_b32 v115, 0xffff0000, v125
    v_lshlrev_b32 v116, 16, v126
    v_and_b32 v117, 0xffff0000, v126
    v_lshlrev_b32 v118, 16, v127
    v_and_b32 v119, 0xffff0000, v127
    v_mul_f32 v112, s71, v112
    v_mul_f32 v113, s71, v113
    v_mul_f32 v114, s71, v114
    v_mul_f32 v115, s71, v115
    v_mul_f32 v116, s71, v116
    v_mul_f32 v117, s71, v117
    v_mul_f32 v118, s71, v118
    v_mul_f32 v119, s71, v119
    v_cvt_pk_bf16_f32 v124, v112, v113
    v_cvt_pk_bf16_f32 v125, v114, v115
    v_cvt_pk_bf16_f32 v126, v116, v117
    v_cvt_pk_bf16_f32 v127, v118, v119
    v_lshlrev_b32 v112, 16, v124
    v_and_b32 v113, 0xffff0000, v124
    v_lshlrev_b32 v114, 16, v125
    v_and_b32 v115, 0xffff0000, v125
    v_lshlrev_b32 v116, 16, v126
    v_and_b32 v117, 0xffff0000, v126
    v_lshlrev_b32 v118, 16, v127
    v_and_b32 v119, 0xffff0000, v127
    v_max_f32 v120, v112, v116
    v_max_f32 v121, v113, v117
    v_max_f32 v122, v114, v118
    v_max_f32 v123, v115, v119
    v_permlane32_swap_b32 v120, v121
    s_nop 0
    v_permlane32_swap_b32 v122, v123
    v_max_f32 v120, v120, v121
    v_max_f32 v122, v122, v123
    s_nop 1
    v_permlane16_swap_b32 v120, v122
    v_max_f32 v120, v120, v122
    s_nop 1
    v_max_f32_dpp v120, v120, v120 row_ror:8 row_mask:0xf bank_mask:0xf
    s_nop 1
    v_max_f32_dpp v120, v120, v120 row_ror:4 row_mask:0xf bank_mask:0xf
    s_nop 1
    v_max_f32_dpp v120, v120, v120 row_ror:2 row_mask:0xf bank_mask:0xf
    s_nop 1
    v_max_f32_dpp v120, v120, v120 row_ror:1 row_mask:0xf bank_mask:0xf
    s_nop 0
    v_readlane_b32 s72, v120, 0
    v_readlane_b32 s74, v120, 16
    v_readlane_b32 s73, v120, 32
    v_readlane_b32 s75, v120, 48
    s_mov_b32 s71, 0x3fb8aa3b
    v_subrev_f32 v112, s72, v112
    v_subrev_f32 v113, s73, v113
    v_subrev_f32 v114, s74, v114
    v_subrev_f32 v115, s75, v115
    v_subrev_f32 v116, s72, v116
    v_subrev_f32 v117, s73, v117
    v_subrev_f32 v118, s74, v118
    v_subrev_f32 v119, s75, v119
    v_mul_f32 v112, s71, v112
    v_mul_f32 v113, s71, v113
    v_mul_f32 v114, s71, v114
    v_mul_f32 v115, s71, v115
    v_mul_f32 v116, s71, v116
    v_mul_f32 v117, s71, v117
    v_mul_f32 v118, s71, v118
    v_mul_f32 v119, s71, v119
    v_exp_f32 v112, v112
    v_exp_f32 v113, v113
    v_exp_f32 v114, v114
    v_exp_f32 v115, v115
    v_exp_f32 v116, v116
    v_exp_f32 v117, v117
    v_exp_f32 v118, v118
    v_exp_f32 v119, v119
    v_mov_b32 v24, v120
    v_add_f32 v120, v112, v116
    v_add_f32 v121, v113, v117
    v_add_f32 v122, v114, v118
    v_add_f32 v123, v115, v119
    v_permlane32_swap_b32 v120, v121
    s_nop 0
    v_permlane32_swap_b32 v122, v123
    v_add_f32 v120, v120, v121
    v_add_f32 v122, v122, v123
    s_nop 1
    v_permlane16_swap_b32 v120, v122
    v_add_f32 v120, v120, v122
    s_nop 1
    v_add_f32_dpp v120, v120, v120 row_ror:8 row_mask:0xf bank_mask:0xf
    s_nop 1
    v_add_f32_dpp v120, v120, v120 row_ror:4 row_mask:0xf bank_mask:0xf
    s_nop 1
    v_add_f32_dpp v120, v120, v120 row_ror:2 row_mask:0xf bank_mask:0xf
    s_nop 1
    v_add_f32_dpp v120, v120, v120 row_ror:1 row_mask:0xf bank_mask:0xf
    v_mov_b32 v25, v120
    v_lshlrev_b32 v121, 4, v12
    s_lshl_b32 s69, s29, 8
    s_lshl_b32 s76, s30, 6
    s_add_u32 s69, s69, s76
    s_add_u32 s69, s69, s70
    s_mov_b32 exec_lo, 0x10001
    s_mov_b32 exec_hi, 0x10001
    s_cmp_eq_u32 s31, 2
    s_cbranch_scc0 L_pl5
    buffer_store_dwordx4 v[24:27], v121, s[48:51], s69 offen
L_pe6:
    s_mov_b64 exec, -1
    v_lshrrev_b32 v32, 2, v7
    v_and_b32 v33, 3, v0
    v_and_b32 v35, 1, v6
    v_lshrrev_b32 v34, 1, v32
    v_lshl_or_b32 v34, v35, 1, v34
    v_lshlrev_b32 v34, 5, v34
    v_lshl_add_u32 v34, v33, 3, v34
    v_lshl_add_u32 v34, v32, 7, v34
    v_lshl_add_u32 v34, v6, 10, v34
    v_add_u32 v60, s67, v34
    v_xor_b32 v61, 32, v60
    v_xor_b32 v62, 64, v60
    v_xor_b32 v63, 0x60, v60
    v_writelane_b32 v106, s72, 0
    v_writelane_b32 v106, s73, 1
    v_writelane_b32 v106, s74, 2
    v_writelane_b32 v106, s75, 3
    v_and_b32 v107, 3, v0
    v_lshl_add_u32 v107, v107, 3, v20
    s_cmp_lg_u32 s30, 0
    s_cbranch_scc1 L_ml7
    s_mov_b32 s62, 0
    buffer_load_dwordx4 v[96:99], v1, s[48:51], s70 offen sc1
    buffer_load_dwordx4 v[100:103], v1, s[48:51], s70 offen offset:1024 sc1
    s_waitcnt vmcnt(3)
    v_add_u32 v28, s67, v1
    ds_write_b128 v28, v[128:131] offset:0
    ds_write_b128 v28, v[132:135] offset:1024
    ds_write_b128 v28, v[136:139] offset:2048
    ds_write_b128 v28, v[140:143] offset:3072
    ds_write_b128 v28, v[144:147] offset:4096
    ds_write_b128 v28, v[148:151] offset:5120
    ds_write_b128 v28, v[152:155] offset:6144
    ds_write_b128 v28, v[156:159] offset:7168
    s_waitcnt lgkmcnt(0)
    ds_read_b64_tr_b16 v[128:129], v60 offset:0
    ds_read_b64_tr_b16 v[130:131], v60 offset:512
    ds_read_b64_tr_b16 v[132:133], v61 offset:0
    ds_read_b64_tr_b16 v[134:135], v61 offset:512
    ds_read_b64_tr_b16 v[136:137], v62 offset:0
    ds_read_b64_tr_b16 v[138:139], v62 offset:512
    ds_read_b64_tr_b16 v[140:141], v63 offset:0
    ds_read_b64_tr_b16 v[142:143], v63 offset:512
    ds_read_b64_tr_b16 v[144:145], v60 offset:4096
    ds_read_b64_tr_b16 v[146:147], v60 offset:4608
    ds_read_b64_tr_b16 v[148:149], v61 offset:4096
    ds_read_b64_tr_b16 v[150:151], v61 offset:4608
    ds_read_b64_tr_b16 v[152:153], v62 offset:4096
    ds_read_b64_tr_b16 v[154:155], v62 offset:4608
    ds_read_b64_tr_b16 v[156:157], v63 offset:4096
    ds_read_b64_tr_b16 v[158:159], v63 offset:4608
    s_branch L_mgc11
L_mg9:
    s_mov_b64 exec, s[40:41]
    s_cbranch_execz L_mgs12
    buffer_load_dwordx4 v[96:99], v1, s[48:51], s70 offen sc1
    buffer_load_dwordx4 v[100:103], v1, s[48:51], s70 offen offset:1024 sc1
L_mgs12:
    s_mov_b64 exec, -1
L_mgc11:
    s_add_u32 s62, s62, 1
    s_waitcnt vmcnt(0)
    v_xor_b32 v104, v98, v26
    v_xor_b32 v105, v99, v27
    v_bitop3_b32 v104, v102, v26, v104 bitop3:0xbe
    v_bitop3_b32 v105, v103, v27, v105 bitop3:0xbe
    v_or_b32 v105, v104, v105
    v_cmp_ne_u32 s[40:41], 0, v105
    s_nop 0
    s_cmp_lg_u64 s[40:41], 0
    s_cbranch_scc0 L_mgd10
    s_sleep 1
    s_cmp_lt_u32 s62, 200000
    s_cbranch_scc1 L_mg9
L_mgd10:
    v_max_f32 v104, v96, v100
    s_nop 1
    v_max_f32_dpp v104, v104, v104 row_ror:4 row_mask:0xf bank_mask:0xf
    s_nop 1
    v_max_f32_dpp v104, v104, v104 row_ror:8 row_mask:0xf bank_mask:0xf
    v_mov_b32 v105, v104
    s_nop 1
    v_permlane16_swap_b32 v104, v105
    v_max_f32 v104, v104, v105
    v_mov_b32 v105, v104
    s_nop 1
    v_permlane32_swap_b32 v104, v105
    v_max_f32 v104, v104, v105
    v_sub_f32 v96, v96, v104
    v_sub_f32 v100, v100, v104
    v_mul_f32 v96, s71, v96
    v_mul_f32 v100, s71, v100
    v_exp_f32 v96, v96
    v_exp_f32 v100, v100
    v_mul_f32 v97, v96, v97
    v_fmac_f32 v97, v100, v101
    s_nop 1
    v_add_f32_dpp v97, v97, v97 row_ror:4 row_mask:0xf bank_mask:0xf
    s_nop 1
    v_add_f32_dpp v97, v97, v97 row_ror:8 row_mask:0xf bank_mask:0xf
    v_mov_b32 v105, v97
    s_nop 1
    v_permlane16_swap_b32 v97, v105
    v_add_f32 v97, v97, v105
    v_mov_b32 v105, v97
    s_nop 1
    v_permlane32_swap_b32 v97, v105
    v_add_f32 v97, v97, v105
    v_rcp_f32 v105, v97
    s_nop 0
    ds_write_b64 v107, v[104:105] offset:96
    ds_write_b32 v20, v19 offset:24
    s_branch L_ml8
L_ml7:
    s_waitcnt vmcnt(1)
    v_add_u32 v28, s67, v1
    ds_write_b128 v28, v[128:131] offset:0
    ds_write_b128 v28, v[132:135] offset:1024
    ds_write_b128 v28, v[136:139] offset:2048
    ds_write_b128 v28, v[140:143] offset:3072
    ds_write_b128 v28, v[144:147] offset:4096
    ds_write_b128 v28, v[148:151] offset:5120
    ds_write_b128 v28, v[152:155] offset:6144
    ds_write_b128 v28, v[156:159] offset:7168
    s_waitcnt lgkmcnt(0)
    ds_read_b64_tr_b16 v[128:129], v60 offset:0
    ds_read_b64_tr_b16 v[130:131], v60 offset:512
    ds_read_b64_tr_b16 v[132:133], v61 offset:0
    ds_read_b64_tr_b16 v[134:135], v61 offset:512
    ds_read_b64_tr_b16 v[136:137], v62 offset:0
    ds_read_b64_tr_b16 v[138:139], v62 offset:512
    ds_read_b64_tr_b16 v[140:141], v63 offset:0
    ds_read_b64_tr_b16 v[142:143], v63 offset:512
    ds_read_b64_tr_b16 v[144:145], v60 offset:4096
    ds_read_b64_tr_b16 v[146:147], v60 offset:4608
    ds_read_b64_tr_b16 v[148:149], v61 offset:4096
    ds_read_b64_tr_b16 v[150:151], v61 offset:4608
    ds_read_b64_tr_b16 v[152:153], v62 offset:4096
    ds_read_b64_tr_b16 v[154:155], v62 offset:4608
    ds_read_b64_tr_b16 v[156:157], v63 offset:4096
    ds_read_b64_tr_b16 v[158:159], v63 offset:4608
    s_mov_b32 s62, 0
L_lw13:
    ds_read_b32 v104, v20 offset:24
    s_add_u32 s62, s62, 1
    s_waitcnt lgkmcnt(0)
    v_readfirstlane_b32 s76, v104
    s_nop 0
    s_cmp_ge_u32 s76, 1
    s_cbranch_scc1 L_lwd14
    s_sleep 1
    s_cmp_lt_u32 s62, 800000
    s_cbranch_scc1 L_lw13
L_lwd14:
    ds_read_b64 v[104:105], v107 offset:96
    s_waitcnt lgkmcnt(0)
L_ml8:
    v_sub_f32 v106, v106, v104
    v_mul_f32 v106, s71, v106
    v_exp_f32 v106, v106
    s_nop 0
    v_mul_f32 v106, v106, v105
    s_nop 0
    v_readlane_b32 s72, v106, 0
    v_readlane_b32 s73, v106, 1
    v_readlane_b32 s74, v106, 2
    v_readlane_b32 s75, v106, 3
    v_and_b32 v104, 3, v7
    v_lshlrev_b32 v104, 3, v104
    v_lshrrev_b32 v105, 2, v7
    v_lshl_add_u32 v104, v105, 1, v104
    v_lshl_add_u32 v104, v6, 7, v104
    s_lshl_b32 s69, s30, 10
    s_add_u32 s69, s69, 131072
    v_add_u32 v104, s69, v104
    v_mul_f32 v112, s72, v112
    v_mul_f32 v113, s73, v113
    v_mul_f32 v114, s74, v114
    v_mul_f32 v115, s75, v115
    v_mul_f32 v116, s72, v116
    v_mul_f32 v117, s73, v117
    v_mul_f32 v118, s74, v118
    v_mul_f32 v119, s75, v119
    v_cvt_pk_bf16_f32 v124, v112, v113
    v_cvt_pk_bf16_f32 v125, v114, v115
    v_cvt_pk_bf16_f32 v126, v116, v117
    v_cvt_pk_bf16_f32 v127, v118, v119
    ds_write_b16 v104, v124 offset:0
    ds_write_b16_d16_hi v104, v124 offset:32
    ds_write_b16 v104, v125 offset:64
    ds_write_b16_d16_hi v104, v125 offset:96
    ds_write_b16 v104, v126 offset:512
    ds_write_b16_d16_hi v104, v126 offset:544
    ds_write_b16 v104, v127 offset:576
    ds_write_b16_d16_hi v104, v127 offset:608
    ds_write_b32 v21, v19 offset:32
    s_waitcnt vmcnt(0)
    v_lshlrev_b32 v34, 5, v35
    v_lshl_add_u32 v34, v33, 3, v34
    v_lshl_add_u32 v34, v32, 6, v34
    v_lshl_add_u32 v34, v6, 9, v34
    v_add_u32 v46, s67, v34
    v_xor_b32 v47, 32, v46
    v_lshl_or_b32 v34, v35, 2, v32
    v_lshlrev_b32 v34, 5, v34
    v_lshl_add_u32 v34, v33, 3, v34
    v_lshl_add_u32 v34, v32, 8, v34
    v_lshl_add_u32 v34, v6, 11, v34
    v_add_u32 v48, s67, v34
    v_xor_b32 v49, 32, v48
    v_xor_b32 v50, 64, v48
    v_xor_b32 v51, 96, v48
    v_xor_b32 v52, 128, v48
    v_xor_b32 v53, 160, v48
    v_xor_b32 v54, 192, v48
    v_xor_b32 v55, 224, v48
    s_movk_i32 s44, 0x3ff
    v_bfe_u32 v56, v26, 3, 10
    v_bfe_u32 v57, v26, 13, 10
    v_bfe_u32 v58, v27, 0, 10
    v_bfe_u32 v59, v27, 10, 10
    v_lshlrev_b32 v30, 4, v7
    v_lshl_add_u32 v30, v6, 11, v30
    s_lshl_b32 s69, s30, 9
    v_add_u32 v30, s69, v30
    s_lshl_b32 s69, s30, 8
    s_add_u32 s69, s69, 152064
    v_lshl_add_u32 v31, v13, 1, s69
    v_lshl_add_u32 v32, v6, 4, s69
    s_add_u32 s69, s69, 1024
    v_lshl_add_u32 v33, v0, 2, s69
    v_add_u32 v34, 153088, v1
    v_lshlrev_b32 v35, 3, v0
    v_lshlrev_b32 v22, 16, v22
    v_lshlrev_b32 v23, 16, v23
    v_lshlrev_b32 v36, 2, v14
    v_add_u32 v36, 154624, v36
    v_lshrrev_b32 v37, 5, v0
    v_lshlrev_b32 v37, 2, v37
    s_lshl_b32 s69, s30, 3
    s_add_u32 s69, s69, 154112
    v_add_u32 v37, s69, v37
    v_mov_b32 v38, 154112
    v_and_b32 v41, 31, v0
    v_lshlrev_b32 v39, 2, v41
    v_add_u32 v39, 156672, v39
    s_lshl_b32 s69, s30, 6
    s_add_u32 s69, s69, 158720
    v_lshl_add_u32 v40, v41, 1, s69
    v_lshl_add_u32 v41, v6, 4, s69
    v_lshlrev_b32 v29, 4, v6
    v_add_u32 v29, 158976, v29
    v_and_b32 v18, 1, v0
    v_cmp_eq_u32 vcc, 0, v18
    s_nop 1
    v_cndmask_b32 v29, v29, v32, vcc
    v_lshlrev_b32 v18, 2, v0
    v_add_u32 v18, 158976, v18
    v_mov_b32 v24, 0x3f803f80
    ds_write_b32 v18, v24
    s_lshl_b32 s69, s30, 9
    s_add_u32 s69, s69, 156672
    v_lshl_add_u32 v18, v0, 3, s69
    v_and_b32 v39, 31, v0
    v_lshlrev_b32 v39, 3, v39
    v_add_u32 v39, 156672, v39
    s_lshl_b32 s78, s63, 14
    s_add_u32 s78, s78, 0xc0000
    s_add_u32 s79, s78, 8192
    s_lshl_b32 s60, s28, 14
    s_add_u32 s60, s60, 0x20000
    s_add_u32 s61, s60, 8192
    s_lshl_b32 s66, s26, 11
    s_add_u32 s66, s66, s60
    s_lshl_b32 s76, s29, 8
    s_add_u32 s66, s66, s76
    s_mul_i32 s68, s28, 56
    s_add_u32 s68, s68, s77
    s_lshl_b32 s68, s68, 11
    s_add_u32 s68, s68, 0x140000
    s_lshl_b32 s76, s30, 9
    s_add_u32 s68, s68, s76
    s_mul_i32 s52, s28, 114688
    s_add_u32 s52, s52, 0x140000
    s_lshl_b32 s76, s26, 2
    s_add_u32 s76, s76, s29
    s_lshl_b32 s69, s76, 6
    s_add_u32 s52, s52, s69
    s_add_u32 s53, s52, 0x8000
    s_add_u32 s54, s52, 0x10000
    s_add_u32 s55, s52, 0x18000
    v_lshrrev_b32 v42, 2, v0
    v_lshlrev_b32 v42, 11, v42
    v_and_b32 v43, 3, v0
    v_lshl_add_u32 v42, v43, 4, v42
    s_lshr_b32 s69, s76, 3
    s_lshl_b32 s69, s69, 7
    s_and_b32 s76, s76, 7
    s_lshl_b32 s76, s76, 3
    s_add_u32 s69, s69, s76
    v_lshlrev_b32 v43, 1, v43
    v_and_b32 v44, 1, v6
    v_add_u32 v43, v43, v44
    v_lshrrev_b32 v44, 5, v0
    v_lshl_add_u32 v43, v44, 6, v43
    v_add_u32 v43, s69, v43
    v_and_b32 v43, 0x1ff, v43
    v_lshlrev_b32 v44, 2, v43
    v_add_u32 v44, 154624, v44
    s_lshl_b32 s69, s28, 10
    v_lshl_add_u32 v43, v43, 1, s69
    s_mov_b32 s69, 0x3b000000
    v_mov_b32 v92, 0
    v_mov_b32 v93, 0
    v_mov_b32 v94, 0
    v_mov_b32 v95, 0
    s_cmp_ge_u32 s30, 2
    s_cbranch_scc1 L_w215
    s_mov_b32 s32, s16
    s_and_b32 s33, s17, 0xffff
    s_mov_b32 s34, 0x1c0000
    s_mov_b32 s35, 0x20000
    v_lshrrev_b32 v10, 3, v0
    v_mul_u32_u24 v10, 3584, v10
    v_and_b32 v11, 7, v0
    v_lshl_add_u32 v10, v11, 6, v10
    s_lshl_b32 s73, s27, 1
    s_add_u32 s73, s73, s30
    s_mul_i32 s73, s73, 28672
    s_mul_i32 s72, s26, 448
    s_and_b32 s72, s72, -128
    s_add_u32 s73, s73, s72
    s_branch L_we16
L_w215:
    s_lshl_b32 s73, s26, 5
    s_add_u32 s73, s73, s27
    s_mul_i32 s73, s73, 7168
    s_add_u32 s34, s73, 7168
    s_mov_b32 s32, s18
    s_and_b32 s33, s19, 0xffff
    s_mov_b32 s35, 0x20000
    s_and_b32 s72, s30, 1
    s_lshl_b32 s72, s72, 12
    s_add_u32 s73, s73, s72
    v_lshlrev_b32 v10, 6, v0
L_we16:
    s_mov_b32 s62, 0
L_lw17:
    ds_read_b32 v24, v20 offset:28
    s_add_u32 s62, s62, 1
    s_waitcnt lgkmcnt(0)
    v_readfirstlane_b32 s76, v24
    s_nop 0
    s_cmp_ge_u32 s76, 4
    s_cbranch_scc1 L_lwd18
    s_sleep 1
    s_cmp_lt_u32 s62, 800000
    s_cbranch_scc1 L_lw17
L_lwd18:
    buffer_load_dword v11, v10, s[32:35], s73 offen
L_sw19:
    s_lshl_b32 s76, s30, 9
    s_add_u32 s76, s76, 135168
    v_add_u32 v15, s76, v1
    s_lshl_b32 s74, s29, 11
    s_add_u32 s74, s74, s78
    s_lshl_b32 s76, s30, 9
    s_add_u32 s74, s74, s76
    s_mov_b32 s62, 0
L_lw20:
    ds_read_b32 v24, v20 offset:48
    s_add_u32 s62, s62, 1
    s_waitcnt lgkmcnt(0)
    v_readfirstlane_b32 s76, v24
    s_nop 0
    s_cmp_ge_u32 s76, 4
    s_cbranch_scc1 L_lwd21
    s_cmp_lt_u32 s62, 800000
    s_cbranch_scc1 L_lw20
L_lwd21:
    s_mov_b32 exec_lo, 0xffffffff
    s_mov_b32 exec_hi, 0x0
    ds_read_b128 v[96:99], v15 offset:0
    ds_read_b128 v[100:103], v15 offset:2048
    ds_read_b128 v[104:107], v15 offset:4096
    ds_read_b128 v[108:111], v15 offset:6144
    s_waitcnt lgkmcnt(0)
    v_pk_add_f32 v[96:97], v[96:97], v[104:105]
    v_pk_add_f32 v[98:99], v[98:99], v[106:107]
    v_pk_add_f32 v[100:101], v[100:101], v[108:109]
    v_pk_add_f32 v[102:103], v[102:103], v[110:111]
    v_pk_add_f32 v[96:97], v[96:97], v[100:101]
    v_pk_add_f32 v[98:99], v[98:99], v[102:103]
    v_add_u32 v96, 0x200, v96
    v_add_u32 v97, 0x200, v97
    v_add_u32 v98, 0x200, v98
    v_add_u32 v99, 0x200, v99
    v_bfi_b32 v96, s44, v56, v96
    v_bfi_b32 v97, s44, v57, v97
    v_bfi_b32 v98, s44, v58, v98
    v_bfi_b32 v99, s44, v59, v99
    s_cmp_eq_u32 s31, 2
    s_cbranch_scc0 L_pl22
    buffer_store_dwordx4 v[96:99], v1, s[48:51], s74 offen
L_pe23:
    s_mov_b64 exec, -1
    s_mov_b32 s62, 0
    s_mov_b64 s[40:41], -1
    s_mov_b64 s[42:43], -1
    buffer_load_dwordx4 v[64:67], v30, s[48:51], s78 offen offset:0 sc1
    buffer_load_dwordx4 v[68:71], v30, s[48:51], s78 offen offset:256 sc1
    buffer_load_dwordx4 v[72:75], v30, s[48:51], s79 offen offset:0 sc1
    buffer_load_dwordx4 v[76:79], v30, s[48:51], s79 offen offset:256 sc1
    ds_read_b64_tr_b16 v[160:161], v60 offset:8192
    ds_read_b64_tr_b16 v[162:163], v60 offset:8704
    ds_read_b64_tr_b16 v[164:165], v61 offset:8192
    ds_read_b64_tr_b16 v[166:167], v61 offset:8704
    ds_read_b64_tr_b16 v[168:169], v62 offset:8192
    ds_read_b64_tr_b16 v[170:171], v62 offset:8704
    ds_read_b64_tr_b16 v[172:173], v63 offset:8192
    ds_read_b64_tr_b16 v[174:175], v63 offset:8704
    ds_read_b64_tr_b16 v[176:177], v60 offset:12288
    ds_read_b64_tr_b16 v[178:179], v60 offset:12800
    ds_read_b64_tr_b16 v[180:181], v61 offset:12288
    ds_read_b64_tr_b16 v[182:183], v61 offset:12800
    ds_read_b64_tr_b16 v[184:185], v62 offset:12288
    ds_read_b64_tr_b16 v[186:187], v62 offset:12800
    ds_read_b64_tr_b16 v[188:189], v63 offset:12288
    ds_read_b64_tr_b16 v[190:191], v63 offset:12800
    s_branch L_mgc26
L_mg24:
    s_mov_b64 exec, s[40:41]
    s_cbranch_execz L_mgs27
    buffer_load_dwordx4 v[64:67], v30, s[48:51], s78 offen offset:0 sc1
    buffer_load_dwordx4 v[68:71], v30, s[48:51], s78 offen offset:256 sc1
L_mgs27:
    s_mov_b64 exec, s[42:43]
    s_cbranch_execz L_mgs28
    buffer_load_dwordx4 v[72:75], v30, s[48:51], s79 offen offset:0 sc1
    buffer_load_dwordx4 v[76:79], v30, s[48:51], s79 offen offset:256 sc1
L_mgs28:
L_mgc26:
    s_add_u32 s62, s62, 1
    s_mov_b64 exec, s[40:41]
    s_waitcnt vmcnt(0)
    v_xor_b32 v64, v64, v56
    v_xor_b32 v65, v65, v57
    v_xor_b32 v66, v66, v58
    v_xor_b32 v67, v67, v59
    v_xor_b32 v68, v68, v56
    v_xor_b32 v69, v69, v57
    v_xor_b32 v70, v70, v58
    v_xor_b32 v71, v71, v59
    s_mov_b64 exec, s[42:43]
    v_xor_b32 v72, v72, v56
    v_xor_b32 v73, v73, v57
    v_xor_b32 v74, v74, v58
    v_xor_b32 v75, v75, v59
    v_xor_b32 v76, v76, v56
    v_xor_b32 v77, v77, v57
    v_xor_b32 v78, v78, v58
    v_xor_b32 v79, v79, v59
    s_mov_b64 exec, -1
    v_or3_b32 v96, v64, v65, v66
    v_or_b32 v96, v96, v67
    v_or3_b32 v97, v68, v69, v70
    v_or_b32 v97, v97, v71
    v_or3_b32 v98, v72, v73, v74
    v_or_b32 v98, v98, v75
    v_or3_b32 v99, v76, v77, v78
    v_or_b32 v99, v99, v79
    v_bitop3_b32 v97, v96, v97, s44 bitop3:0xa8
    v_bitop3_b32 v99, v98, v99, s44 bitop3:0xa8
    v_cmp_ne_u32 s[40:41], 0, v97
    v_cmp_ne_u32 s[42:43], 0, v99
    s_nop 0
    s_or_b64 vcc, s[40:41], s[42:43]
    s_cbranch_scc0 L_mgd25
    s_cmp_lt_u32 s62, 200000
    s_cbranch_scc1 L_mg24
L_mgd25:
    s_mov_b32 exec_lo, 0x1
    s_mov_b32 exec_hi, 0x0
    ds_add_u32 v20, v19 offset:52
    s_mov_b64 exec, -1
    v_pk_add_f32 v[64:65], v[64:65], v[72:73]
    v_pk_add_f32 v[66:67], v[66:67], v[74:75]
    v_pk_add_f32 v[68:69], v[68:69], v[76:77]
    v_pk_add_f32 v[70:71], v[70:71], v[78:79]
    v_permlane32_swap_b32 v64, v65
    v_permlane32_swap_b32 v66, v67
    v_permlane32_swap_b32 v68, v69
    v_permlane32_swap_b32 v70, v71
    v_add_f32 v64, v64, v65
    v_add_f32 v66, v66, v67
    v_add_f32 v68, v68, v69
    v_add_f32 v70, v70, v71
    v_permlane16_swap_b32 v64, v66
    s_nop 0
    v_permlane16_swap_b32 v68, v70
    v_add_f32 v64, v64, v66
    v_add_f32 v68, v68, v70
    v_cvt_pk_bf16_f32 v96, v64, v68
    ds_write_b16 v31, v96
    ds_write_b16_d16_hi v31, v96 offset:128
    ds_read_b128 v[96:99], v32 offset:0
    ds_read_b128 v[100:103], v32 offset:64
    ds_read_b128 v[104:107], v32 offset:128
    ds_read_b128 v[108:111], v32 offset:192
    s_waitcnt lgkmcnt(3)
    v_mfma_f32_16x16x32_bf16 v[112:115], v[96:99], v[128:131], 0
    v_mfma_f32_16x16x32_bf16 v[116:119], v[96:99], v[132:135], 0
    v_mfma_f32_16x16x32_bf16 v[120:123], v[96:99], v[136:139], 0
    v_mfma_f32_16x16x32_bf16 v[124:127], v[96:99], v[140:143], 0
    s_waitcnt lgkmcnt(2)
    v_mfma_f32_16x16x32_bf16 v[112:115], v[100:103], v[144:147], v[112:115]
    v_mfma_f32_16x16x32_bf16 v[116:119], v[100:103], v[148:151], v[116:119]
    v_mfma_f32_16x16x32_bf16 v[120:123], v[100:103], v[152:155], v[120:123]
    v_mfma_f32_16x16x32_bf16 v[124:127], v[100:103], v[156:159], v[124:127]
    s_waitcnt lgkmcnt(1)
    v_mfma_f32_16x16x32_bf16 v[112:115], v[104:107], v[160:163], v[112:115]
    v_mfma_f32_16x16x32_bf16 v[116:119], v[104:107], v[164:167], v[116:119]
    v_mfma_f32_16x16x32_bf16 v[120:123], v[104:107], v[168:171], v[120:123]
    v_mfma_f32_16x16x32_bf16 v[124:127], v[104:107], v[172:175], v[124:127]
    s_waitcnt lgkmcnt(0)
    v_mfma_f32_16x16x32_bf16 v[112:115], v[108:111], v[176:179], v[112:115]
    v_mfma_f32_16x16x32_bf16 v[116:119], v[108:111], v[180:183], v[116:119]
    v_mfma_f32_16x16x32_bf16 v[120:123], v[108:111], v[184:187], v[120:123]
    v_mfma_f32_16x16x32_bf16 v[124:127], v[108:111], v[188:191], v[124:127]
    s_nop 5
    v_mov_b32_dpp v112, v116 quad_perm:[0,1,2,3] row_mask:0x2 bank_mask:0xf
    v_mov_b32_dpp v112, v120 quad_perm:[0,1,2,3] row_mask:0x4 bank_mask:0xf
    v_mov_b32_dpp v112, v124 quad_perm:[0,1,2,3] row_mask:0x8 bank_mask:0xf
    ds_write_b32 v33, v112
    s_waitcnt lgkmcnt(0)
    s_barrier
    s_cmp_lg_u32 s30, 0
    s_cbranch_scc1 L_nopub29
    s_mov_b32 exec_lo, 0xffff
    s_mov_b32 exec_hi, 0x0
    ds_read_b128 v[96:99], v34 offset:0
    ds_read_b128 v[100:103], v34 offset:256
    ds_read_b128 v[104:107], v34 offset:512
    ds_read_b128 v[108:111], v34 offset:768
    s_waitcnt lgkmcnt(0)
    v_pk_add_f32 v[96:97], v[96:97], v[104:105]
    v_pk_add_f32 v[98:99], v[98:99], v[106:107]
    v_pk_add_f32 v[100:101], v[100:101], v[108:109]
    v_pk_add_f32 v[102:103], v[102:103], v[110:111]
    v_pk_add_f32 v[96:97], v[96:97], v[100:101]
    v_pk_add_f32 v[98:99], v[98:99], v[102:103]
    v_add_u32 v96, 0x200, v96
    v_add_u32 v97, 0x200, v97
    v_add_u32 v98, 0x200, v98
    v_add_u32 v99, 0x200, v99
    v_bfi_b32 v96, s44, v56, v96
    v_bfi_b32 v97, s44, v57, v97
    v_bfi_b32 v98, s44, v58, v98
    v_bfi_b32 v99, s44, v59, v99
    buffer_store_dwordx4 v[96:99], v1, s[48:51], s66 offen sc1
    s_mov_b64 exec, -1
    ds_write_b32 v20, v19 offset:12
L_nopub29:
    s_cmp_eq_u32 s29, 7
    s_cbranch_scc1 L_fin
    s_mov_b32 s62, 0
L_lw30:
    ds_read_b32 v24, v20 offset:20
    s_add_u32 s62, s62, 1
    s_waitcnt lgkmcnt(0)
    v_readfirstlane_b32 s76, v24
    s_nop 0
    s_cmp_ge_u32 s76, 4
    s_cbranch_scc1 L_lwd31
    s_cmp_lt_u32 s62, 800000
    s_cbranch_scc1 L_lw30
L_lwd31:
    s_mov_b32 s62, 0
    s_mov_b64 s[40:41], -1
    s_mov_b64 s[42:43], -1
    buffer_load_dwordx4 v[64:67], v30, s[48:51], s60 offen offset:0 sc1
    buffer_load_dwordx4 v[68:71], v30, s[48:51], s60 offen offset:256 sc1
    buffer_load_dwordx4 v[72:75], v30, s[48:51], s61 offen offset:0 sc1
    buffer_load_dwordx4 v[76:79], v30, s[48:51], s61 offen offset:256 sc1
    s_mov_b32 exec_lo, 0x1
    s_mov_b32 exec_hi, 0x0
    ds_add_u32 v20, v19 offset:4
    s_mov_b64 exec, -1
    s_mov_b32 s45, s62
    s_mov_b32 s62, 0
L_lw35:
    ds_read_b32 v24, v20 offset:128
    s_add_u32 s62, s62, 1
    s_waitcnt lgkmcnt(0)
    v_readfirstlane_b32 s76, v24
    s_nop 0
    s_cmp_ge_u32 s76, 4
    s_cbranch_scc1 L_lwd36
    s_cmp_lt_u32 s62, 800000
    s_cbranch_scc1 L_lw35
L_lwd36:
    s_mov_b32 s62, s45
    ds_read_b64_tr_b16 v[192:193], v46 offset:16384
    ds_read_b64_tr_b16 v[194:195], v46 offset:16640
    ds_read_b64_tr_b16 v[196:197], v47 offset:16384
    ds_read_b64_tr_b16 v[198:199], v47 offset:16640
    ds_read_b64_tr_b16 v[200:201], v46 offset:18432
    ds_read_b64_tr_b16 v[202:203], v46 offset:18688
    ds_read_b64_tr_b16 v[204:205], v47 offset:18432
    ds_read_b64_tr_b16 v[206:207], v47 offset:18688
    ds_read_b64_tr_b16 v[208:209], v46 offset:20480
    ds_read_b64_tr_b16 v[210:211], v46 offset:20736
    ds_read_b64_tr_b16 v[212:213], v47 offset:20480
    ds_read_b64_tr_b16 v[214:215], v47 offset:20736
    ds_read_b64_tr_b16 v[216:217], v46 offset:22528
    ds_read_b64_tr_b16 v[218:219], v46 offset:22784
    ds_read_b64_tr_b16 v[220:221], v47 offset:22528
    ds_read_b64_tr_b16 v[222:223], v47 offset:22784
    s_branch L_mgc34
L_mg32:
    s_mov_b64 exec, s[40:41]
    s_cbranch_execz L_mgs37
    buffer_load_dwordx4 v[64:67], v30, s[48:51], s60 offen offset:0 sc1
    buffer_load_dwordx4 v[68:71], v30, s[48:51], s60 offen offset:256 sc1
L_mgs37:
    s_mov_b64 exec, s[42:43]
    s_cbranch_execz L_mgs38
    buffer_load_dwordx4 v[72:75], v30, s[48:51], s61 offen offset:0 sc1
    buffer_load_dwordx4 v[76:79], v30, s[48:51], s61 offen offset:256 sc1
L_mgs38:
L_mgc34:
    s_add_u32 s62, s62, 1
    s_mov_b64 exec, s[40:41]
    s_waitcnt vmcnt(0)
    v_xor_b32 v64, v64, v56
    v_xor_b32 v65, v65, v57
    v_xor_b32 v66, v66, v58
    v_xor_b32 v67, v67, v59
    v_xor_b32 v68, v68, v56
    v_xor_b32 v69, v69, v57
    v_xor_b32 v70, v70, v58
    v_xor_b32 v71, v71, v59
    s_mov_b64 exec, s[42:43]
    v_xor_b32 v72, v72, v56
    v_xor_b32 v73, v73, v57
    v_xor_b32 v74, v74, v58
    v_xor_b32 v75, v75, v59
    v_xor_b32 v76, v76, v56
    v_xor_b32 v77, v77, v57
    v_xor_b32 v78, v78, v58
    v_xor_b32 v79, v79, v59
    s_mov_b64 exec, -1
    v_or3_b32 v96, v64, v65, v66
    v_or_b32 v96, v96, v67
    v_or3_b32 v97, v68, v69, v70
    v_or_b32 v97, v97, v71
    v_or3_b32 v98, v72, v73, v74
    v_or_b32 v98, v98, v75
    v_or3_b32 v99, v76, v77, v78
    v_or_b32 v99, v99, v79
    v_bitop3_b32 v97, v96, v97, s44 bitop3:0xa8
    v_bitop3_b32 v99, v98, v99, s44 bitop3:0xa8
    v_cmp_ne_u32 s[40:41], 0, v97
    v_cmp_ne_u32 s[42:43], 0, v99
    s_nop 0
    s_or_b64 vcc, s[40:41], s[42:43]
    s_cbranch_scc0 L_mgd33
    s_cmp_lt_u32 s62, 200000
    s_cbranch_scc1 L_mg32
L_mgd33:
    v_pk_add_f32 v[64:65], v[64:65], v[72:73]
    v_pk_add_f32 v[66:67], v[66:67], v[74:75]
    v_pk_add_f32 v[68:69], v[68:69], v[76:77]
    v_pk_add_f32 v[70:71], v[70:71], v[78:79]
    v_permlane32_swap_b32 v64, v65
    v_permlane32_swap_b32 v66, v67
    v_permlane32_swap_b32 v68, v69
    v_permlane32_swap_b32 v70, v71
    v_add_f32 v64, v64, v65
    v_add_f32 v66, v66, v67
    v_add_f32 v68, v68, v69
    v_add_f32 v70, v70, v71
    v_permlane16_swap_b32 v64, v66
    s_nop 0
    v_permlane16_swap_b32 v68, v70
    v_add_f32 v64, v64, v66
    v_add_f32 v68, v68, v70
    v_cvt_pk_bf16_f32 v96, v64, v68
    v_lshlrev_b32 v97, 16, v96
    v_and_b32 v98, 0xffff0000, v96
    v_add_f32 v97, v97, v22
    v_add_f32 v98, v98, v23
    v_cvt_pk_bf16_f32 v96, v97, v98
    ds_write_b16 v31, v96
    ds_write_b16_d16_hi v31, v96 offset:128
    ds_read_b128 v[64:67], v29 offset:0
    ds_read_b128 v[68:71], v29 offset:64
    ds_read_b128 v[72:75], v29 offset:128
    ds_read_b128 v[76:79], v29 offset:192
    v_lshlrev_b32 v97, 16, v96
    v_and_b32 v98, 0xffff0000, v96
    v_add_f32 v99, v97, v98
    v_mul_f32 v100, v97, v97
    v_fmac_f32 v100, v98, v98
    ds_write_b32 v36, v97
    ds_write_b32 v36, v98 offset:256
    v_permlane32_swap_b32 v99, v100
    v_add_f32 v99, v99, v100
    v_mov_b32 v100, v99
    s_nop 1
    v_permlane16_swap_b32 v99, v100
    v_add_f32 v99, v99, v100
    s_waitcnt lgkmcnt(5)
    v_mfma_f32_16x16x32_bf16 v[112:115], v[64:67], v[192:195], 0
    v_mfma_f32_16x16x32_bf16 v[116:119], v[64:67], v[196:199], 0
    v_add_f32_dpp v99, v99, v99 row_ror:8 row_mask:0xf bank_mask:0xf
    s_waitcnt lgkmcnt(4)
    v_mfma_f32_16x16x32_bf16 v[112:115], v[68:71], v[200:203], v[112:115]
    v_mfma_f32_16x16x32_bf16 v[116:119], v[68:71], v[204:207], v[116:119]
    v_add_f32_dpp v99, v99, v99 row_ror:4 row_mask:0xf bank_mask:0xf
    s_waitcnt lgkmcnt(3)
    v_mfma_f32_16x16x32_bf16 v[112:115], v[72:75], v[208:211], v[112:115]
    v_mfma_f32_16x16x32_bf16 v[116:119], v[72:75], v[212:215], v[116:119]
    v_add_f32_dpp v99, v99, v99 row_ror:2 row_mask:0xf bank_mask:0xf
    s_waitcnt lgkmcnt(2)
    v_mfma_f32_16x16x32_bf16 v[112:115], v[76:79], v[216:219], v[112:115]
    v_mfma_f32_16x16x32_bf16 v[116:119], v[76:79], v[220:223], v[116:119]
    v_add_f32_dpp v99, v99, v99 row_ror:1 row_mask:0xf bank_mask:0xf
    ds_write_b32 v37, v99
    s_nop 5
    v_mov_b32_dpp v112, v116 quad_perm:[0,1,2,3] row_mask:0x2 bank_mask:0xf
    v_mov_b32_dpp v113, v117 quad_perm:[0,1,2,3] row_mask:0x2 bank_mask:0xf
    ds_write_b64 v18, v[112:113]
    s_waitcnt lgkmcnt(0)
    s_barrier
    ds_read_b128 v[100:103], v38
    ds_read_b128 v[104:107], v38 offset:16
    ds_read_b64 v[108:109], v39 offset:0
    ds_read_b64 v[110:111], v39 offset:512
    ds_read_b64 v[112:113], v39 offset:1024
    ds_read_b64 v[114:115], v39 offset:1536
    ds_read_b32 v45, v44
    ds_read_b64_tr_b16 v[224:225], v48 offset:24576
    ds_read_b64_tr_b16 v[226:227], v48 offset:25600
    ds_read_b64_tr_b16 v[228:229], v49 offset:24576
    ds_read_b64_tr_b16 v[230:231], v49 offset:25600
    ds_read_b64_tr_b16 v[232:233], v50 offset:24576
    ds_read_b64_tr_b16 v[234:235], v50 offset:25600
    ds_read_b64_tr_b16 v[236:237], v51 offset:24576
    ds_read_b64_tr_b16 v[238:239], v51 offset:25600
    ds_read_b64_tr_b16 v[240:241], v52 offset:24576
    ds_read_b64_tr_b16 v[242:243], v52 offset:25600
    ds_read_b64_tr_b16 v[244:245], v53 offset:24576
    ds_read_b64_tr_b16 v[246:247], v53 offset:25600
    ds_read_b64_tr_b16 v[248:249], v54 offset:24576
    ds_read_b64_tr_b16 v[250:251], v54 offset:25600
    ds_read_b64_tr_b16 v[252:253], v55 offset:24576
    ds_read_b64_tr_b16 v[254:255], v55 offset:25600
    s_waitcnt lgkmcnt(15)
    v_pk_add_f32 v[100:101], v[100:101], v[102:103]
    v_pk_add_f32 v[104:105], v[104:105], v[106:107]
    v_pk_add_f32 v[108:109], v[108:109], v[110:111]
    v_pk_add_f32 v[112:113], v[112:113], v[114:115]
    v_pk_add_f32 v[100:101], v[100:101], v[104:105]
    v_pk_add_f32 v[108:109], v[108:109], v[112:113]
    v_mul_f32 v100, s69, v100
    v_mul_f32 v101, s69, v101
    v_fma_f32 v101, -v100, v100, v101
    v_max_f32 v101, 0, v101
    v_cvt_pk_bf16_f32 v102, v100, v101
    v_and_b32 v101, 0xffff0000, v102
    v_lshlrev_b32 v100, 16, v102
    v_add_f32 v101, 0x3727c5ac, v101
    v_fma_f32 v96, -v100, v109, v108
    v_cvt_pk_bf16_f32 v101, v101, v101
    v_and_b32 v101, 0xffff0000, v101
    v_sqrt_f32 v101, v101
    s_nop 0
    v_cvt_pk_bf16_f32 v101, v101, v101
    v_and_b32 v101, 0xffff0000, v101
    v_rcp_f32 v101, v101
    s_nop 0
    v_mul_f32 v96, v96, v101
    v_cvt_pk_bf16_f32 v96, v96, v96
    v_and_b32 v96, 0xffff0000, v96
    v_mul_f32 v97, s71, v96
    v_exp_f32 v97, -v97
    s_nop 0
    v_add_f32 v97, 1.0, v97
    v_rcp_f32 v97, v97
    s_nop 0
    v_mul_f32 v96, v96, v97
    v_cvt_pk_bf16_f32 v96, v96, v96
    ds_write_b16 v40, v96
    ds_read_b128 v[96:99], v41
    s_waitcnt lgkmcnt(0)
    v_mfma_f32_16x16x32_bf16 v[100:103], v[96:99], v[224:227], 0
    v_mfma_f32_16x16x32_bf16 v[104:107], v[96:99], v[228:231], 0
    v_mfma_f32_16x16x32_bf16 v[108:111], v[96:99], v[232:235], 0
    v_mfma_f32_16x16x32_bf16 v[112:115], v[96:99], v[236:239], 0
    v_mfma_f32_16x16x32_bf16 v[116:119], v[96:99], v[240:243], 0
    v_mfma_f32_16x16x32_bf16 v[120:123], v[96:99], v[244:247], 0
    v_mfma_f32_16x16x32_bf16 v[124:127], v[96:99], v[248:251], 0
    v_mfma_f32_16x16x32_bf16 v[64:67], v[96:99], v[252:255], 0
    s_nop 0
    v_mov_b32_dpp v68, v100 quad_perm:[0,1,2,3] row_mask:0x1 bank_mask:0xf
    v_mov_b32_dpp v68, v104 quad_perm:[0,1,2,3] row_mask:0x2 bank_mask:0xf
    v_mov_b32_dpp v68, v108 quad_perm:[0,1,2,3] row_mask:0x4 bank_mask:0xf
    v_mov_b32_dpp v68, v112 quad_perm:[0,1,2,3] row_mask:0x8 bank_mask:0xf
    v_mov_b32_dpp v69, v116 quad_perm:[0,1,2,3] row_mask:0x1 bank_mask:0xf
    v_mov_b32_dpp v69, v120 quad_perm:[0,1,2,3] row_mask:0x2 bank_mask:0xf
    v_mov_b32_dpp v69, v124 quad_perm:[0,1,2,3] row_mask:0x4 bank_mask:0xf
    v_mov_b32_dpp v69, v64 quad_perm:[0,1,2,3] row_mask:0x8 bank_mask:0xf
    v_mov_b32_dpp v70, v68 quad_perm:[1,1,3,3] row_mask:0xf bank_mask:0xf
    s_nop 0
    v_mov_b32_dpp v71, v69 quad_perm:[1,1,3,3] row_mask:0xf bank_mask:0xf
    v_bfi_b32 v68, s44, v56, v68
    v_bfi_b32 v69, s44, v57, v69
    v_bfi_b32 v70, s44, v58, v70
    v_bfi_b32 v71, s44, v59, v71
    s_mov_b32 exec_lo, 0x55555555
    s_mov_b32 exec_hi, 0x55555555
    buffer_store_dwordx4 v[68:71], v35, s[48:51], s68 offen sc1
    s_mov_b64 exec, -1
    s_cmp_ge_u32 s29, 4
    s_cbranch_scc1 L_fin
    s_cmp_lg_u32 s30, 0
    s_cbranch_scc1 L_fin
    s_waitcnt vmcnt(0)
    s_mov_b32 s62, 0
    s_mov_b64 s[40:41], -1
L_mg39:
    s_mov_b64 exec, s[40:41]
    s_cbranch_execz L_mgs42
    buffer_load_dwordx4 v[80:83], v42, s[48:51], s52 offen sc1
    buffer_load_dwordx4 v[84:87], v42, s[48:51], s53 offen sc1
    buffer_load_dwordx4 v[88:91], v42, s[48:51], s54 offen sc1
    s_mov_b32 exec_hi, 0
    s_cbranch_execz L_cs43
    buffer_load_dwordx4 v[92:95], v42, s[48:51], s55 offen sc1
L_cs43:
L_mgs42:
L_mgc41:
    s_add_u32 s62, s62, 1
    s_mov_b64 exec, s[40:41]
    s_waitcnt vmcnt(0)
    v_xor_b32 v80, v80, v56
    v_xor_b32 v81, v81, v57
    v_xor_b32 v82, v82, v58
    v_xor_b32 v83, v83, v59
    v_xor_b32 v84, v84, v56
    v_xor_b32 v85, v85, v57
    v_xor_b32 v86, v86, v58
    v_xor_b32 v87, v87, v59
    v_xor_b32 v88, v88, v56
    v_xor_b32 v89, v89, v57
    v_xor_b32 v90, v90, v58
    v_xor_b32 v91, v91, v59
    s_mov_b32 exec_hi, 0
    v_xor_b32 v92, v92, v56
    v_xor_b32 v93, v93, v57
    v_xor_b32 v94, v94, v58
    v_xor_b32 v95, v95, v59
    s_mov_b64 exec, -1
    v_or3_b32 v96, v80, v81, v82
    v_or3_b32 v96, v96, v83, v84
    v_or3_b32 v96, v96, v85, v86
    v_or_b32 v96, v96, v87
    v_or3_b32 v97, v88, v89, v90
    v_or3_b32 v97, v97, v91, v92
    v_or3_b32 v97, v97, v93, v94
    v_or_b32 v97, v97, v95
    v_bitop3_b32 v97, v96, v97, s44 bitop3:0xa8
    v_cmp_ne_u32 s[40:41], 0, v97
    s_nop 0
    s_cmp_lg_u64 s[40:41], 0
    s_cbranch_scc0 L_mgd40
    s_cmp_lt_u32 s62, 200000
    s_cbranch_scc1 L_mg39
L_mgd40:
    v_pk_add_f32 v[80:81], v[80:81], v[88:89]
    v_pk_add_f32 v[82:83], v[82:83], v[90:91]
    v_pk_add_f32 v[84:85], v[84:85], v[92:93]
    v_pk_add_f32 v[86:87], v[86:87], v[94:95]
    v_pk_add_f32 v[80:81], v[80:81], v[84:85]
    v_pk_add_f32 v[82:83], v[82:83], v[86:87]
    s_nop 0
    v_permlane32_swap_b32 v80, v81
    v_permlane32_swap_b32 v82, v83
    v_add_f32 v80, v80, v81
    v_add_f32 v82, v82, v83
    s_nop 1
    v_permlane16_swap_b32 v80, v82
    v_add_f32 v80, v80, v82
    s_nop 1
    v_add_f32_dpp v80, v80, v80 row_ror:4 row_mask:0xf bank_mask:0xf
    s_nop 1
    v_add_f32_dpp v80, v80, v80 row_ror:8 row_mask:0xf bank_mask:0xf
    v_cvt_pk_bf16_f32 v96, v80, v80
    v_and_b32 v96, 0xffff0000, v96
    v_add_f32 v96, v96, v45
    v_cvt_pk_bf16_f32 v96, v96, v96
    s_mov_b32 exec_lo, 0xf000f
    s_mov_b32 exec_hi, 0xf000f
    global_store_short v43, v96, s[20:21]
    s_cmp_lg_u32 s2, 0
    s_cbranch_scc1 L_nep44
    ds_read_b64 v[24:25], v20 offset:64
    v_mov_b32 v26, 0
    s_waitcnt lgkmcnt(0)
    s_mov_b32 exec_lo, 0x1
    s_mov_b32 exec_hi, 0x0
    global_store_dwordx2 v26, v[24:25], s[24:25] sc1
L_nep44:
    s_branch L_fin
L_vstart2:
    s_mov_b32 s48, s24
    s_and_b32 s49, s25, 0xffff
    s_cmp_eq_u32 s3, 4
    s_cbranch_scc1 L_qwave2
    s_cmp_lg_u32 s3, 9
    s_cbranch_scc1 L_w345
    v_lshrrev_b32 v23, 1, v0
    v_lshlrev_b32 v23, 10, v23
    v_and_b32 v24, 1, v0
    v_lshl_add_u32 v23, v24, 6, v23
    s_lshl_b32 s71, s26, 19
    s_lshl_b32 s76, s27, 14
    s_add_u32 s71, s71, s76
    s_add_u32 s71, s71, 384
    s_mov_b32 s36, s12
    s_and_b32 s37, s13, 0xffff
    s_mov_b32 exec_lo, 0xffffffff
    s_mov_b32 exec_hi, 0x0
    buffer_load_dword v25, v23, s[36:39], s71 offen
    s_mov_b64 exec, -1
L_w345:
    s_waitcnt vmcnt(0)
    s_mov_b32 exec_lo, 0x1
    s_mov_b32 exec_hi, 0x0
    ds_add_u32 v20, v19 offset:0
    s_mov_b64 exec, -1
    s_branch L_vmain
L_qwave2:
    v_lshrrev_b32 v32, 2, v7
    v_and_b32 v33, 3, v0
    v_and_b32 v35, 1, v6
    v_lshrrev_b32 v34, 1, v32
    v_lshl_or_b32 v34, v35, 1, v34
    v_lshlrev_b32 v34, 5, v34
    v_lshl_add_u32 v34, v33, 3, v34
    v_lshl_add_u32 v34, v32, 7, v34
    v_lshl_add_u32 v34, v6, 10, v34
    v_add_u32 v36, 131072, v34
    v_xor_b32 v37, 32, v36
    v_xor_b32 v38, 64, v36
    v_xor_b32 v39, 0x60, v36
    v_and_b32 v12, 1, v6
    v_lshlrev_b32 v12, 1, v12
    v_lshrrev_b32 v13, 1, v6
    v_or_b32 v12, v12, v13
    v_lshl_add_u32 v13, v7, 2, v12
    v_lshlrev_b32 v13, 1, v13
    v_add_u32 v13, 148736, v13
    v_lshlrev_b32 v14, 4, v7
    v_lshl_add_u32 v14, v6, 12, v14
    s_lshl_b32 s70, s63, 14
    s_add_u32 s70, s70, 0x40000
    v_and_b32 v4, 3, v7
    v_lshlrev_b32 v4, 17, v4
    v_lshrrev_b32 v5, 2, v7
    v_lshl_add_u32 v4, v5, 6, v4
    v_lshl_add_u32 v4, v6, 4, v4
    s_lshl_b32 s73, s26, 14
    s_lshl_b32 s76, s28, 12
    s_add_u32 s73, s73, s76
    s_lshl_b32 s76, s75, 9
    s_add_u32 s73, s73, s76
    s_add_u32 s73, s73, 0x40000
    s_getreg_b32 s74, hwreg(HW_REG_XCC_ID, 0, 3)
    s_waitcnt vmcnt(5)
    v_lshlrev_b32 v96, 16, v64
    v_and_b32 v97, 0xffff0000, v64
    v_lshlrev_b32 v98, 16, v65
    v_and_b32 v99, 0xffff0000, v65
    v_lshlrev_b32 v100, 16, v66
    v_and_b32 v101, 0xffff0000, v66
    v_lshlrev_b32 v102, 16, v67
    v_and_b32 v103, 0xffff0000, v67
    v_lshlrev_b32 v104, 16, v68
    v_and_b32 v105, 0xffff0000, v68
    v_lshlrev_b32 v106, 16, v69
    v_and_b32 v107, 0xffff0000, v69
    v_lshlrev_b32 v108, 16, v70
    v_and_b32 v109, 0xffff0000, v70
    v_lshlrev_b32 v110, 16, v71
    v_and_b32 v111, 0xffff0000, v71
    v_lshlrev_b32 v112, 16, v72
    v_and_b32 v113, 0xffff0000, v72
    v_lshlrev_b32 v114, 16, v73
    v_and_b32 v115, 0xffff0000, v73
    v_lshlrev_b32 v116, 16, v74
    v_and_b32 v117, 0xffff0000, v74
    v_lshlrev_b32 v118, 16, v75
    v_and_b32 v119, 0xffff0000, v75
    v_lshlrev_b32 v120, 16, v76
    v_and_b32 v121, 0xffff0000, v76
    v_lshlrev_b32 v122, 16, v77
    v_and_b32 v123, 0xffff0000, v77
    v_lshlrev_b32 v124, 16, v78
    v_and_b32 v125, 0xffff0000, v78
    v_lshlrev_b32 v126, 16, v79
    v_and_b32 v127, 0xffff0000, v79
    v_pk_add_f32 v[128:129], v[96:97], v[112:113]
    v_pk_add_f32 v[130:131], v[98:99], v[114:115]
    v_pk_add_f32 v[132:133], v[100:101], v[116:117]
    v_pk_add_f32 v[134:135], v[102:103], v[118:119]
    v_pk_add_f32 v[136:137], v[104:105], v[120:121]
    v_pk_add_f32 v[138:139], v[106:107], v[122:123]
    v_pk_add_f32 v[140:141], v[108:109], v[124:125]
    v_pk_add_f32 v[142:143], v[110:111], v[126:127]
    v_pk_add_f32 v[128:129], v[128:129], v[136:137]
    v_pk_add_f32 v[130:131], v[130:131], v[138:139]
    v_pk_add_f32 v[132:133], v[132:133], v[140:141]
    v_pk_add_f32 v[134:135], v[134:135], v[142:143]
    v_pk_add_f32 v[128:129], v[128:129], v[132:133]
    v_pk_add_f32 v[130:131], v[130:131], v[134:135]
    v_pk_add_f32 v[128:129], v[128:129], v[130:131]
    v_add_f32 v128, v128, v129
    s_nop 1
    v_add_f32_dpp v128, v128, v128 row_ror:8 row_mask:0xf bank_mask:0xf
    s_nop 1
    v_add_f32_dpp v128, v128, v128 row_ror:4 row_mask:0xf bank_mask:0xf
    s_nop 1
    v_add_f32_dpp v128, v128, v128 row_ror:2 row_mask:0xf bank_mask:0xf
    s_nop 1
    v_add_f32_dpp v128, v128, v128 row_ror:1 row_mask:0xf bank_mask:0xf
    s_mov_b32 s69, 0x3b000000
    v_mul_f32 v144, s69, v128
    v_sub_f32 v160, v96, v144
    v_sub_f32 v161, v97, v144
    v_sub_f32 v162, v98, v144
    v_sub_f32 v163, v99, v144
    v_sub_f32 v164, v100, v144
    v_sub_f32 v165, v101, v144
    v_sub_f32 v166, v102, v144
    v_sub_f32 v167, v103, v144
    v_sub_f32 v168, v104, v144
    v_sub_f32 v169, v105, v144
    v_sub_f32 v170, v106, v144
    v_sub_f32 v171, v107, v144
    v_sub_f32 v172, v108, v144
    v_sub_f32 v173, v109, v144
    v_sub_f32 v174, v110, v144
    v_sub_f32 v175, v111, v144
    v_sub_f32 v176, v112, v144
    v_sub_f32 v177, v113, v144
    v_sub_f32 v178, v114, v144
    v_sub_f32 v179, v115, v144
    v_sub_f32 v180, v116, v144
    v_sub_f32 v181, v117, v144
    v_sub_f32 v182, v118, v144
    v_sub_f32 v183, v119, v144
    v_sub_f32 v184, v120, v144
    v_sub_f32 v185, v121, v144
    v_sub_f32 v186, v122, v144
    v_sub_f32 v187, v123, v144
    v_sub_f32 v188, v124, v144
    v_sub_f32 v189, v125, v144
    v_sub_f32 v190, v126, v144
    v_sub_f32 v191, v127, v144
    v_mul_f32 v128, v160, v160
    v_mul_f32 v129, v161, v161
    v_fmac_f32 v128, v162, v162
    v_fmac_f32 v129, v163, v163
    v_fmac_f32 v128, v164, v164
    v_fmac_f32 v129, v165, v165
    v_fmac_f32 v128, v166, v166
    v_fmac_f32 v129, v167, v167
    v_fmac_f32 v128, v168, v168
    v_fmac_f32 v129, v169, v169
    v_fmac_f32 v128, v170, v170
    v_fmac_f32 v129, v171, v171
    v_fmac_f32 v128, v172, v172
    v_fmac_f32 v129, v173, v173
    v_fmac_f32 v128, v174, v174
    v_fmac_f32 v129, v175, v175
    v_fmac_f32 v128, v176, v176
    v_fmac_f32 v129, v177, v177
    v_fmac_f32 v128, v178, v178
    v_fmac_f32 v129, v179, v179
    v_fmac_f32 v128, v180, v180
    v_fmac_f32 v129, v181, v181
    v_fmac_f32 v128, v182, v182
    v_fmac_f32 v129, v183, v183
    v_fmac_f32 v128, v184, v184
    v_fmac_f32 v129, v185, v185
    v_fmac_f32 v128, v186, v186
    v_fmac_f32 v129, v187, v187
    v_fmac_f32 v128, v188, v188
    v_fmac_f32 v129, v189, v189
    v_fmac_f32 v128, v190, v190
    v_fmac_f32 v129, v191, v191
    v_add_f32 v128, v128, v129
    s_nop 1
    v_add_f32_dpp v128, v128, v128 row_ror:8 row_mask:0xf bank_mask:0xf
    s_nop 1
    v_add_f32_dpp v128, v128, v128 row_ror:4 row_mask:0xf bank_mask:0xf
    s_nop 1
    v_add_f32_dpp v128, v128, v128 row_ror:2 row_mask:0xf bank_mask:0xf
    s_nop 1
    v_add_f32_dpp v128, v128, v128 row_ror:1 row_mask:0xf bank_mask:0xf
    v_mul_f32 v145, s69, v128
    v_cvt_pk_bf16_f32 v146, v144, v145
    v_lshlrev_b32 v144, 16, v146
    v_and_b32 v145, 0xffff0000, v146
    v_add_f32 v145, 0x3727c5ac, v145
    v_cvt_pk_bf16_f32 v145, v145, v145
    v_and_b32 v145, 0xffff0000, v145
    v_sqrt_f32 v145, v145
    v_sub_f32 v96, v96, v144
    v_sub_f32 v97, v97, v144
    v_sub_f32 v98, v98, v144
    v_sub_f32 v99, v99, v144
    v_sub_f32 v100, v100, v144
    v_sub_f32 v101, v101, v144
    v_sub_f32 v102, v102, v144
    v_sub_f32 v103, v103, v144
    v_cvt_pk_bf16_f32 v145, v145, v145
    v_and_b32 v145, 0xffff0000, v145
    v_rcp_f32 v145, v145
    v_cvt_pk_bf16_f32 v64, v96, v97
    v_cvt_pk_bf16_f32 v65, v98, v99
    v_cvt_pk_bf16_f32 v66, v100, v101
    v_cvt_pk_bf16_f32 v67, v102, v103
    v_lshlrev_b32 v96, 16, v64
    v_and_b32 v97, 0xffff0000, v64
    v_lshlrev_b32 v98, 16, v65
    v_and_b32 v99, 0xffff0000, v65
    v_lshlrev_b32 v100, 16, v66
    v_and_b32 v101, 0xffff0000, v66
    v_lshlrev_b32 v102, 16, v67
    v_and_b32 v103, 0xffff0000, v67
    v_mul_f32 v96, v96, v145
    v_mul_f32 v97, v97, v145
    v_mul_f32 v98, v98, v145
    v_mul_f32 v99, v99, v145
    v_mul_f32 v100, v100, v145
    v_mul_f32 v101, v101, v145
    v_mul_f32 v102, v102, v145
    v_mul_f32 v103, v103, v145
    v_cvt_pk_bf16_f32 v64, v96, v97
    v_cvt_pk_bf16_f32 v65, v98, v99
    v_cvt_pk_bf16_f32 v66, v100, v101
    v_cvt_pk_bf16_f32 v67, v102, v103
    v_mul_u32_u24 v5, 320, v6
    v_lshl_add_u32 v5, v7, 4, v5
    v_add_u32 v5, 147456, v5
    ds_write_b128 v5, v[64:67]
    v_and_b32 v5, 3, v7
    v_mul_u32_u24 v5, 320, v5
    v_lshl_add_u32 v5, v6, 4, v5
    v_add_u32 v5, 147456, v5
    ds_read_b128 v[112:115], v5 offset:0
    ds_read_b128 v[116:119], v5 offset:64
    ds_read_b128 v[120:123], v5 offset:128
    ds_read_b128 v[124:127], v5 offset:192
    s_waitcnt vmcnt(4)
    v_readfirstlane_b32 s78, v8
    v_readfirstlane_b32 s79, v9
    s_mul_hi_u32 s71, s78, 0x4c957f2d
    s_mul_i32 s72, s78, 0x5851f42d
    s_mul_i32 s79, s79, 0x4c957f2d
    s_mul_i32 s78, s78, 0x4c957f2d
    s_add_u32 s71, s71, s72
    s_add_u32 s79, s79, s71
    s_add_u32 s78, s78, 0xf767814f
    s_addc_u32 s79, s79, 0x14057b7e
    s_and_b32 s71, s78, -8
    s_or_b32 s72, s71, s74
    v_mov_b32 v8, s71
    v_mov_b32 v9, s79
    v_mov_b32 v10, s78
    v_mov_b32 v11, s79
    ds_write_b64 v20, v[8:9] offset:56
    ds_write_b64 v20, v[10:11] offset:64
    v_mov_b32 v26, s72
    v_mov_b32 v27, s79
    v_mov_b32 v30, s72
    v_mov_b32 v31, s79
    s_waitcnt vmcnt(0)
    s_mov_b32 s62, 0
L_lw46:
    ds_read_b32 v24, v20 offset:0
    s_add_u32 s62, s62, 1
    s_waitcnt lgkmcnt(0)
    v_readfirstlane_b32 s76, v24
    s_nop 0
    s_cmp_ge_u32 s76, 3
    s_cbranch_scc1 L_lwd47
    s_cmp_lt_u32 s62, 800000
    s_cbranch_scc1 L_lw46
L_lwd47:
    ds_read_b64_tr_b16 v[128:129], v36 offset:0
    ds_read_b64_tr_b16 v[130:131], v36 offset:512
    ds_read_b64_tr_b16 v[132:133], v37 offset:0
    ds_read_b64_tr_b16 v[134:135], v37 offset:512
    ds_read_b64_tr_b16 v[136:137], v38 offset:0
    ds_read_b64_tr_b16 v[138:139], v38 offset:512
    ds_read_b64_tr_b16 v[140:141], v39 offset:0
    ds_read_b64_tr_b16 v[142:143], v39 offset:512
    ds_read_b64_tr_b16 v[144:145], v36 offset:4096
    ds_read_b64_tr_b16 v[146:147], v36 offset:4608
    ds_read_b64_tr_b16 v[148:149], v37 offset:4096
    ds_read_b64_tr_b16 v[150:151], v37 offset:4608
    ds_read_b64_tr_b16 v[152:153], v38 offset:4096
    ds_read_b64_tr_b16 v[154:155], v38 offset:4608
    ds_read_b64_tr_b16 v[156:157], v39 offset:4096
    ds_read_b64_tr_b16 v[158:159], v39 offset:4608
    ds_read_b64_tr_b16 v[160:161], v36 offset:8192
    ds_read_b64_tr_b16 v[162:163], v36 offset:8704
    ds_read_b64_tr_b16 v[164:165], v37 offset:8192
    ds_read_b64_tr_b16 v[166:167], v37 offset:8704
    ds_read_b64_tr_b16 v[168:169], v38 offset:8192
    ds_read_b64_tr_b16 v[170:171], v38 offset:8704
    ds_read_b64_tr_b16 v[172:173], v39 offset:8192
    ds_read_b64_tr_b16 v[174:175], v39 offset:8704
    ds_read_b64_tr_b16 v[176:177], v36 offset:12288
    ds_read_b64_tr_b16 v[178:179], v36 offset:12800
    ds_read_b64_tr_b16 v[180:181], v37 offset:12288
    ds_read_b64_tr_b16 v[182:183], v37 offset:12800
    ds_read_b64_tr_b16 v[184:185], v38 offset:12288
    ds_read_b64_tr_b16 v[186:187], v38 offset:12800
    ds_read_b64_tr_b16 v[188:189], v39 offset:12288
    ds_read_b64_tr_b16 v[190:191], v39 offset:12800
    s_waitcnt lgkmcnt(15)
    v_mfma_f32_16x16x32_bf16 v[96:99], v[128:131], v[112:115], 0
    v_mfma_f32_16x16x32_bf16 v[100:103], v[132:135], v[112:115], 0
    v_mfma_f32_16x16x32_bf16 v[104:107], v[136:139], v[112:115], 0
    v_mfma_f32_16x16x32_bf16 v[108:111], v[140:143], v[112:115], 0
    s_waitcnt lgkmcnt(15)
    v_mfma_f32_16x16x32_bf16 v[96:99], v[144:147], v[116:119], v[96:99]
    v_mfma_f32_16x16x32_bf16 v[100:103], v[148:151], v[116:119], v[100:103]
    v_mfma_f32_16x16x32_bf16 v[104:107], v[152:155], v[116:119], v[104:107]
    v_mfma_f32_16x16x32_bf16 v[108:111], v[156:159], v[116:119], v[108:111]
    s_waitcnt lgkmcnt(8)
    v_mfma_f32_16x16x32_bf16 v[96:99], v[160:163], v[120:123], v[96:99]
    v_mfma_f32_16x16x32_bf16 v[100:103], v[164:167], v[120:123], v[100:103]
    v_mfma_f32_16x16x32_bf16 v[104:107], v[168:171], v[120:123], v[104:107]
    v_mfma_f32_16x16x32_bf16 v[108:111], v[172:175], v[120:123], v[108:111]
    s_waitcnt lgkmcnt(0)
    v_mfma_f32_16x16x32_bf16 v[96:99], v[176:179], v[124:127], v[96:99]
    v_mfma_f32_16x16x32_bf16 v[100:103], v[180:183], v[124:127], v[100:103]
    v_mfma_f32_16x16x32_bf16 v[104:107], v[184:187], v[124:127], v[104:107]
    v_mfma_f32_16x16x32_bf16 v[108:111], v[188:191], v[124:127], v[108:111]
    s_nop 4
    v_mov_b32_dpp v24, v96 quad_perm:[0,1,2,3] row_mask:0xf bank_mask:0x1
    v_mov_b32_dpp v24, v100 quad_perm:[0,1,2,3] row_mask:0xf bank_mask:0x2
    v_mov_b32_dpp v24, v104 quad_perm:[0,1,2,3] row_mask:0xf bank_mask:0x4
    v_mov_b32_dpp v24, v108 quad_perm:[0,1,2,3] row_mask:0xf bank_mask:0x8
    v_mov_b32_dpp v25, v97 quad_perm:[0,1,2,3] row_mask:0xf bank_mask:0x1
    v_mov_b32_dpp v25, v101 quad_perm:[0,1,2,3] row_mask:0xf bank_mask:0x2
    v_mov_b32_dpp v25, v105 quad_perm:[0,1,2,3] row_mask:0xf bank_mask:0x4
    v_mov_b32_dpp v25, v109 quad_perm:[0,1,2,3] row_mask:0xf bank_mask:0x8
    v_mov_b32_dpp v28, v98 quad_perm:[0,1,2,3] row_mask:0xf bank_mask:0x1
    v_mov_b32_dpp v28, v102 quad_perm:[0,1,2,3] row_mask:0xf bank_mask:0x2
    v_mov_b32_dpp v28, v106 quad_perm:[0,1,2,3] row_mask:0xf bank_mask:0x4
    v_mov_b32_dpp v28, v110 quad_perm:[0,1,2,3] row_mask:0xf bank_mask:0x8
    v_mov_b32_dpp v29, v99 quad_perm:[0,1,2,3] row_mask:0xf bank_mask:0x1
    v_mov_b32_dpp v29, v103 quad_perm:[0,1,2,3] row_mask:0xf bank_mask:0x2
    v_mov_b32_dpp v29, v107 quad_perm:[0,1,2,3] row_mask:0xf bank_mask:0x4
    v_mov_b32_dpp v29, v111 quad_perm:[0,1,2,3] row_mask:0xf bank_mask:0x8
    buffer_store_dwordx4 v[24:27], v4, s[48:51], s73 offen
    buffer_store_dwordx4 v[28:31], v4, s[48:51], s73 offen offset:256
    s_waitcnt vmcnt(0)
    s_mov_b32 s62, 0
    s_mov_b64 s[40:41], -1
L_mg48:
    s_cmp_lg_u32 s62, 5
    s_cbranch_scc1 L_rp51
    buffer_store_dwordx4 v[24:27], v4, s[48:51], s73 offen sc1
    buffer_store_dwordx4 v[28:31], v4, s[48:51], s73 offen offset:256 sc1
L_rp51:
    s_mov_b64 exec, s[40:41]
    s_cbranch_execz L_mgs52
    buffer_load_dwordx4 v[64:67], v14, s[48:51], s70 offen offset:0 sc1
    buffer_load_dwordx4 v[68:71], v14, s[48:51], s70 offen offset:256 sc1
    buffer_load_dwordx4 v[72:75], v14, s[48:51], s70 offen offset:512 sc1
    buffer_load_dwordx4 v[76:79], v14, s[48:51], s70 offen offset:768 sc1
    buffer_load_dwordx4 v[80:83], v14, s[48:51], s70 offen offset:1024 sc1
    buffer_load_dwordx4 v[84:87], v14, s[48:51], s70 offen offset:1280 sc1
    buffer_load_dwordx4 v[88:91], v14, s[48:51], s70 offen offset:1536 sc1
    buffer_load_dwordx4 v[92:95], v14, s[48:51], s70 offen offset:1792 sc1
    buffer_load_dwordx4 v[96:99], v14, s[48:51], s70 offen offset:2048 sc1
    buffer_load_dwordx4 v[100:103], v14, s[48:51], s70 offen offset:2304 sc1
    buffer_load_dwordx4 v[104:107], v14, s[48:51], s70 offen offset:2560 sc1
    buffer_load_dwordx4 v[108:111], v14, s[48:51], s70 offen offset:2816 sc1
    buffer_load_dwordx4 v[112:115], v14, s[48:51], s70 offen offset:3072 sc1
    buffer_load_dwordx4 v[116:119], v14, s[48:51], s70 offen offset:3328 sc1
    buffer_load_dwordx4 v[120:123], v14, s[48:51], s70 offen offset:3584 sc1
    buffer_load_dwordx4 v[124:127], v14, s[48:51], s70 offen offset:3840 sc1
L_mgs52:
    s_mov_b64 exec, -1
L_mgc50:
    s_add_u32 s62, s62, 1
    s_waitcnt vmcnt(0)
    v_xor_b32 v32, v66, v26
    v_xor_b32 v33, v67, v27
    v_bitop3_b32 v32, v70, v26, v32 bitop3:0xbe
    v_bitop3_b32 v33, v71, v27, v33 bitop3:0xbe
    v_bitop3_b32 v32, v74, v26, v32 bitop3:0xbe
    v_bitop3_b32 v33, v75, v27, v33 bitop3:0xbe
    v_bitop3_b32 v32, v78, v26, v32 bitop3:0xbe
    v_bitop3_b32 v33, v79, v27, v33 bitop3:0xbe
    v_bitop3_b32 v32, v82, v26, v32 bitop3:0xbe
    v_bitop3_b32 v33, v83, v27, v33 bitop3:0xbe
    v_bitop3_b32 v32, v86, v26, v32 bitop3:0xbe
    v_bitop3_b32 v33, v87, v27, v33 bitop3:0xbe
    v_bitop3_b32 v32, v90, v26, v32 bitop3:0xbe
    v_bitop3_b32 v33, v91, v27, v33 bitop3:0xbe
    v_bitop3_b32 v32, v94, v26, v32 bitop3:0xbe
    v_bitop3_b32 v33, v95, v27, v33 bitop3:0xbe
    v_bitop3_b32 v32, v98, v26, v32 bitop3:0xbe
    v_bitop3_b32 v33, v99, v27, v33 bitop3:0xbe
    v_bitop3_b32 v32, v102, v26, v32 bitop3:0xbe
    v_bitop3_b32 v33, v103, v27, v33 bitop3:0xbe
    v_bitop3_b32 v32, v106, v26, v32 bitop3:0xbe
    v_bitop3_b32 v33, v107, v27, v33 bitop3:0xbe
    v_bitop3_b32 v32, v110, v26, v32 bitop3:0xbe
    v_bitop3_b32 v33, v111, v27, v33 bitop3:0xbe
    v_bitop3_b32 v32, v114, v26, v32 bitop3:0xbe
    v_bitop3_b32 v33, v115, v27, v33 bitop3:0xbe
    v_bitop3_b32 v32, v118, v26, v32 bitop3:0xbe
    v_bitop3_b32 v33, v119, v27, v33 bitop3:0xbe
    v_bitop3_b32 v32, v122, v26, v32 bitop3:0xbe
    v_bitop3_b32 v33, v123, v27, v33 bitop3:0xbe
    v_bitop3_b32 v32, v126, v26, v32 bitop3:0xbe
    v_bitop3_b32 v33, v127, v27, v33 bitop3:0xbe
    v_and_or_b32 v33, v32, -8, v33
    v_cmp_ne_u32 s[40:41], 0, v33
    s_nop 0
    s_cmp_lg_u64 s[40:41], 0
    s_cbranch_scc0 L_mgd49
    s_cmp_lt_u32 s62, 200000
    s_cbranch_scc1 L_mg48
L_mgd49:
    v_cmp_ne_u32 vcc, 0, v32
    s_nop 0
    s_cmp_eq_u64 vcc, 0
    s_cselect_b32 s31, 2, 1
    s_cbranch_scc1 L_rp53
    buffer_store_dwordx4 v[24:27], v4, s[48:51], s73 offen sc1
    buffer_store_dwordx4 v[28:31], v4, s[48:51], s73 offen offset:256 sc1
L_rp53:
    v_permlane32_swap_b32 v64, v65
    v_permlane32_swap_b32 v68, v69
    v_permlane32_swap_b32 v72, v73
    v_permlane32_swap_b32 v76, v77
    v_permlane32_swap_b32 v80, v81
    v_permlane32_swap_b32 v84, v85
    v_permlane32_swap_b32 v88, v89
    v_permlane32_swap_b32 v92, v93
    v_permlane32_swap_b32 v96, v97
    v_permlane32_swap_b32 v100, v101
    v_permlane32_swap_b32 v104, v105
    v_permlane32_swap_b32 v108, v109
    v_permlane32_swap_b32 v112, v113
    v_permlane32_swap_b32 v116, v117
    v_permlane32_swap_b32 v120, v121
    v_permlane32_swap_b32 v124, v125
    v_add_f32 v64, v64, v65
    v_add_f32 v68, v68, v69
    v_add_f32 v72, v72, v73
    v_add_f32 v76, v76, v77
    v_add_f32 v80, v80, v81
    v_add_f32 v84, v84, v85
    v_add_f32 v88, v88, v89
    v_add_f32 v92, v92, v93
    v_add_f32 v96, v96, v97
    v_add_f32 v100, v100, v101
    v_add_f32 v104, v104, v105
    v_add_f32 v108, v108, v109
    v_add_f32 v112, v112, v113
    v_add_f32 v116, v116, v117
    v_add_f32 v120, v120, v121
    v_add_f32 v124, v124, v125
    v_permlane16_swap_b32 v64, v68
    v_permlane16_swap_b32 v72, v76
    v_permlane16_swap_b32 v80, v84
    v_permlane16_swap_b32 v88, v92
    v_permlane16_swap_b32 v96, v100
    v_permlane16_swap_b32 v104, v108
    v_permlane16_swap_b32 v112, v116
    v_permlane16_swap_b32 v120, v124
    v_add_f32 v64, v64, v68
    v_add_f32 v72, v72, v76
    v_add_f32 v80, v80, v84
    v_add_f32 v88, v88, v92
    v_add_f32 v96, v96, v100
    v_add_f32 v104, v104, v108
    v_add_f32 v112, v112, v116
    v_add_f32 v120, v120, v124
    v_cvt_pk_bf16_f32 v64, v64, v72
    v_cvt_pk_bf16_f32 v80, v80, v88
    v_cvt_pk_bf16_f32 v96, v96, v104
    v_cvt_pk_bf16_f32 v112, v112, v120
    ds_write_b16 v13, v64 offset:0
    ds_write_b16_d16_hi v13, v64 offset:128
    ds_write_b16 v13, v80 offset:320
    ds_write_b16_d16_hi v13, v80 offset:448
    ds_write_b16 v13, v96 offset:640
    ds_write_b16_d16_hi v13, v96 offset:768
    ds_write_b16 v13, v112 offset:960
    ds_write_b16_d16_hi v13, v112 offset:1088
    v_mov_b32 v24, s31
    ds_write_b32 v20, v24 offset:8
L_vmain:
    s_setprio 0
    s_add_u32 s32, s8, s64
    s_addc_u32 s33, s9, 0
    s_and_b32 s33, s33, 0xffff
    v_and_b32 v2, 3, v0
    v_lshlrev_b32 v2, 4, v2
    v_mov_b32 v16, 0x0d0c
    v_mov_b32 v17, 0
    v_mov_b32 v18, 0x0f0e
    v_mov_b32 v19, 0
    v_lshlrev_b64 v[16:17], v2, v[16:17]
    v_lshlrev_b64 v[18:19], v2, v[18:19]
    v_xor_b32 v16, 0x0c0c0c0c, v16
    v_xor_b32 v17, 0x0c0c0c0c, v17
    v_xor_b32 v18, 0x0c0c0c0c, v18
    v_xor_b32 v19, 0x0c0c0c0c, v19
    v_lshrrev_b32 v3, 2, v7
    v_lshlrev_b32 v3, 5, v3
    v_lshl_add_u32 v3, v6, 3, v3
    s_lshl_b32 s69, s30, 10
    s_add_u32 s69, s69, 131072
    v_add_u32 v3, s69, v3
    v_lshlrev_b32 v4, 5, v7
    v_lshl_add_u32 v4, v6, 9, v4
    s_lshl_b32 s69, s30, 11
    s_add_u32 s69, s69, 135168
    v_add_u32 v4, s69, v4
    v_add_u32 v5, 135168, v1
    s_lshl_b32 s70, s63, 3
    s_add_u32 s70, s70, s29
    s_lshl_b32 s70, s70, 11
    s_add_u32 s70, s70, 0xc0000
    v_mov_b32 v22, 1
    s_mov_b32 s40, s16
    s_and_b32 s41, s17, 0xffff
    s_mov_b32 s42, 0x1c0000
    s_mov_b32 s43, 0x20000
    s_mov_b32 s44, s18
    s_and_b32 s45, s19, 0xffff
    s_mov_b32 s46, 0x1c0000
    s_mov_b32 s47, 0x20000
    s_movk_i32 s56, 0x3ff
    v_lshrrev_b32 v10, 2, v0
    v_and_b32 v11, 3, v0
    v_and_b32 v25, 2, v6
    v_xor_b32 v11, v11, v25
    v_lshlrev_b32 v11, 4, v11
    v_mul_u32_u24 v10, 3584, v10
    v_add_u32 v26, v10, v11
    s_mul_i32 s73, s30, 458752
    s_lshl_b32 s76, s77, 6
    s_add_u32 s73, s73, s76
    v_lshlrev_b32 v10, 1, v6
    v_xor_b32 v10, v7, v10
    v_lshlrev_b32 v10, 4, v10
    v_lshl_add_u32 v27, v6, 10, v10
    v_xor_b32 v28, 0x80, v27
    s_lshl_b32 s74, s77, 15
    s_lshl_b32 s76, s30, 8
    s_add_u32 s74, s74, s76
    v_lshrrev_b32 v10, 3, v0
    v_and_b32 v11, 7, v0
    v_and_b32 v12, 2, v10
    v_xor_b32 v11, v11, v12
    v_lshlrev_b32 v11, 4, v11
    v_lshl_add_u32 v30, v10, 10, v11
    v_xor_b32 v31, 64, v30
    s_lshl_b32 s72, s26, 19
    s_lshl_b32 s76, s30, 17
    s_add_u32 s72, s72, s76
    s_lshl_b32 s76, s29, 7
    s_add_u32 s72, s72, s76
    s_add_u32 s72, s72, 65536
    s_mov_b32 s36, s12
    s_and_b32 s37, s13, 0xffff
    s_lshl_b32 s57, s30, 15
    s_add_u32 s76, s57, 8192
    s_mov_b32 m0, s76
    s_waitcnt vmcnt(0)
    s_mov_b32 s62, 0
L_lw54:
    ds_read_b32 v24, v20 offset:16
    s_add_u32 s62, s62, 1
    s_waitcnt lgkmcnt(0)
    v_readfirstlane_b32 s76, v24
    s_nop 0
    s_cmp_ge_u32 s76, 4
    s_cbranch_scc1 L_lwd55
    s_sleep 2
    s_cmp_lt_u32 s62, 800000
    s_cbranch_scc1 L_lw54
L_lwd55:
    buffer_load_dwordx4 v[64:67], v1, s[32:35], s65 offen offset:0 nt
    buffer_load_dwordx4 v[68:71], v1, s[32:35], s65 offen offset:1024 nt
    buffer_load_dwordx4 v[72:75], v1, s[32:35], s65 offen offset:2048 nt
    buffer_load_dwordx4 v[76:79], v1, s[32:35], s65 offen offset:3072 nt
    s_add_u32 s65, s65, 131072
    buffer_load_dwordx4 v[80:83], v1, s[32:35], s65 offen offset:0 nt
    buffer_load_dwordx4 v[84:87], v1, s[32:35], s65 offen offset:1024 nt
    buffer_load_dwordx4 v[88:91], v1, s[32:35], s65 offen offset:2048 nt
    s_waitcnt vmcnt(6)
    buffer_load_dwordx4 v[92:95], v1, s[32:35], s65 offen offset:3072 nt
    s_waitcnt vmcnt(6)
    s_add_u32 s65, s65, 131072
    buffer_load_dwordx4 v[96:99], v1, s[32:35], s65 offen offset:0 nt
    s_waitcnt vmcnt(6)
    buffer_load_dwordx4 v[100:103], v1, s[32:35], s65 offen offset:1024 nt
    s_waitcnt vmcnt(6)
    buffer_load_dwordx4 v[104:107], v1, s[32:35], s65 offen offset:2048 nt
    s_waitcnt vmcnt(6)
    buffer_load_dwordx4 v[108:111], v1, s[32:35], s65 offen offset:3072 nt
    s_waitcnt vmcnt(6)
    s_add_u32 s65, s65, 131072
    s_mov_b32 s62, 0
L_lw56:
    ds_read_b32 v24, v21 offset:80
    s_add_u32 s62, s62, 1
    s_waitcnt lgkmcnt(0)
    v_readfirstlane_b32 s76, v24
    s_nop 0
    s_cmp_ge_u32 s76, 1
    s_cbranch_scc1 L_lwd57
    s_sleep 1
    s_cmp_lt_u32 s62, 800000
    s_cbranch_scc1 L_lw56
L_lwd57:
    buffer_load_dwordx4 v[112:115], v1, s[32:35], s65 offen offset:0 nt
    s_waitcnt vmcnt(6)
    buffer_load_dwordx4 v30, s[36:39], s72 offen lds
    s_add_u32 m0, m0, 1024
    s_add_u32 s72, s72, 8192
    s_waitcnt vmcnt(6)
    buffer_load_dwordx4 v[116:119], v1, s[32:35], s65 offen offset:1024 nt
    s_waitcnt vmcnt(6)
    buffer_load_dwordx4 v[120:123], v1, s[32:35], s65 offen offset:2048 nt
    s_waitcnt vmcnt(6)
    buffer_load_dwordx4 v31, s[36:39], s72 offen lds
    s_add_u32 m0, m0, 1024
    s_add_u32 s72, s72, 8192
    s_waitcnt vmcnt(6)
    buffer_load_dwordx4 v[124:127], v1, s[32:35], s65 offen offset:3072 nt
    s_waitcnt vmcnt(6)
    s_add_u32 s65, s65, 131072
    buffer_load_dwordx4 v[128:131], v1, s[32:35], s65 offen offset:0 nt
    s_waitcnt vmcnt(6)
    buffer_load_dwordx4 v30, s[36:39], s72 offen lds
    s_add_u32 m0, m0, 1024
    s_add_u32 s72, s72, 8192
    s_waitcnt vmcnt(6)
    buffer_load_dwordx4 v[132:135], v1, s[32:35], s65 offen offset:1024 nt
    s_waitcnt vmcnt(6)
    buffer_load_dwordx4 v[136:139], v1, s[32:35], s65 offen offset:2048 nt
    s_waitcnt vmcnt(6)
    buffer_load_dwordx4 v[140:143], v1, s[32:35], s65 offen offset:3072 nt
    s_waitcnt vmcnt(6)
    buffer_load_dwordx4 v31, s[36:39], s72 offen lds
    s_add_u32 m0, m0, 1024
    s_add_u32 s72, s72, 8192
    s_waitcnt vmcnt(6)
    s_add_u32 s65, s65, 131072
    buffer_load_dwordx4 v[144:147], v1, s[32:35], s65 offen offset:0 nt
    s_waitcnt vmcnt(6)
    buffer_load_dwordx4 v[148:151], v1, s[32:35], s65 offen offset:1024 nt
    s_waitcnt vmcnt(6)
    buffer_load_dwordx4 v30, s[36:39], s72 offen lds
    s_add_u32 m0, m0, 1024
    s_add_u32 s72, s72, 8192
    s_waitcnt vmcnt(6)
    buffer_load_dwordx4 v[152:155], v1, s[32:35], s65 offen offset:2048 nt
    s_waitcnt vmcnt(6)
    buffer_load_dwordx4 v[156:159], v1, s[32:35], s65 offen offset:3072 nt
    s_waitcnt vmcnt(6)
    buffer_load_dwordx4 v31, s[36:39], s72 offen lds
    s_add_u32 m0, m0, 1024
    s_add_u32 s72, s72, 8192
    s_waitcnt vmcnt(6)
    s_add_u32 s65, s65, 131072
    buffer_load_dwordx4 v[160:163], v1, s[32:35], s65 offen offset:0 nt
    s_waitcnt vmcnt(6)
    buffer_load_dwordx4 v[164:167], v1, s[32:35], s65 offen offset:1024 nt
    s_waitcnt vmcnt(6)
    buffer_load_dwordx4 v[168:171], v1, s[32:35], s65 offen offset:2048 nt
    s_waitcnt vmcnt(6)
    buffer_load_dwordx4 v30, s[36:39], s72 offen lds
    s_add_u32 m0, m0, 1024
    s_add_u32 s72, s72, 8192
    s_waitcnt vmcnt(6)
    buffer_load_dwordx4 v[172:175], v1, s[32:35], s65 offen offset:3072 nt
    s_waitcnt vmcnt(11)
    s_add_u32 s65, s65, 131072
    buffer_load_dwordx4 v[176:179], v1, s[32:35], s65 offen offset:0 nt
    s_waitcnt vmcnt(11)
    buffer_load_dwordx4 v31, s[36:39], s72 offen lds
    s_add_u32 m0, m0, 1024
    s_add_u32 s72, s72, 8192
    s_waitcnt vmcnt(11)
    buffer_load_dwordx4 v[180:183], v1, s[32:35], s65 offen offset:1024 nt
    s_waitcnt vmcnt(11)
    buffer_load_dwordx4 v[184:187], v1, s[32:35], s65 offen offset:2048 nt
    s_waitcnt vmcnt(11)
    buffer_load_dwordx4 v[188:191], v1, s[32:35], s65 offen offset:3072 nt
    s_mov_b32 exec_lo, 0x1
    s_mov_b32 exec_hi, 0x0
    ds_add_u32 v20, v22 offset:28
    s_mov_b64 exec, -1
    s_mov_b32 s62, 0
L_lw58:
    ds_read_b32 v24, v21 offset:32
    s_add_u32 s62, s62, 1
    s_waitcnt lgkmcnt(0)
    v_readfirstlane_b32 s76, v24
    s_nop 0
    s_cmp_ge_u32 s76, 1
    s_cbranch_scc1 L_lwd59
    s_sleep 1
    s_cmp_lt_u32 s62, 800000
    s_cbranch_scc1 L_lw58
L_lwd59:
    s_setprio 3
    ds_read_b32 v24, v20 offset:8
    ds_read_b64 v[196:197], v20 offset:56
    ds_read_b64 v[32:33], v3 offset:0
    ds_read_b64 v[34:35], v3 offset:128
    ds_read_b64 v[36:37], v3 offset:256
    ds_read_b64 v[38:39], v3 offset:384
    ds_read_b64 v[40:41], v3 offset:512
    ds_read_b64 v[42:43], v3 offset:640
    ds_read_b64 v[44:45], v3 offset:768
    ds_read_b64 v[46:47], v3 offset:896
    s_waitcnt lgkmcnt(0)
    v_readfirstlane_b32 s31, v24
    v_bfe_u32 v192, v196, 3, 10
    v_bfe_u32 v193, v196, 13, 10
    v_bfe_u32 v194, v197, 0, 10
    v_bfe_u32 v195, v197, 10, 10
    v_perm_b32 v48, v32, v32, v16
    v_perm_b32 v49, v32, v32, v17
    v_perm_b32 v50, v32, v32, v18
    v_perm_b32 v51, v32, v32, v19
    v_perm_b32 v52, v33, v33, v16
    v_perm_b32 v53, v33, v33, v17
    v_perm_b32 v54, v33, v33, v18
    v_perm_b32 v55, v33, v33, v19
    s_waitcnt vmcnt(36)
    v_mfma_f32_16x16x16_bf16 v[8:11], v[48:49], v[64:65], 0
    v_mfma_f32_16x16x16_bf16 v[12:15], v[48:49], v[66:67], 0
    v_mfma_f32_16x16x16_bf16 v[8:11], v[50:51], v[68:69], v[8:11]
    v_mfma_f32_16x16x16_bf16 v[12:15], v[50:51], v[70:71], v[12:15]
    v_mfma_f32_16x16x16_bf16 v[8:11], v[52:53], v[72:73], v[8:11]
    v_mfma_f32_16x16x16_bf16 v[12:15], v[52:53], v[74:75], v[12:15]
    v_mfma_f32_16x16x16_bf16 v[8:11], v[54:55], v[76:77], v[8:11]
    v_mfma_f32_16x16x16_bf16 v[12:15], v[54:55], v[78:79], v[12:15]
    v_perm_b32 v56, v34, v34, v16
    v_perm_b32 v57, v34, v34, v17
    v_perm_b32 v58, v34, v34, v18
    v_perm_b32 v59, v34, v34, v19
    v_perm_b32 v60, v35, v35, v16
    v_perm_b32 v61, v35, v35, v17
    v_perm_b32 v62, v35, v35, v18
    v_perm_b32 v63, v35, v35, v19
    s_waitcnt vmcnt(32)
    v_mfma_f32_16x16x16_bf16 v[8:11], v[56:57], v[80:81], v[8:11]
    v_mfma_f32_16x16x16_bf16 v[12:15], v[56:57], v[82:83], v[12:15]
    v_mfma_f32_16x16x16_bf16 v[8:11], v[58:59], v[84:85], v[8:11]
    v_mfma_f32_16x16x16_bf16 v[12:15], v[58:59], v[86:87], v[12:15]
    v_mfma_f32_16x16x16_bf16 v[8:11], v[60:61], v[88:89], v[8:11]
    v_mfma_f32_16x16x16_bf16 v[12:15], v[60:61], v[90:91], v[12:15]
    v_mfma_f32_16x16x16_bf16 v[8:11], v[62:63], v[92:93], v[8:11]
    v_mfma_f32_16x16x16_bf16 v[12:15], v[62:63], v[94:95], v[12:15]
    v_perm_b32 v48, v36, v36, v16
    v_perm_b32 v49, v36, v36, v17
    v_perm_b32 v50, v36, v36, v18
    v_perm_b32 v51, v36, v36, v19
    v_perm_b32 v52, v37, v37, v16
    v_perm_b32 v53, v37, v37, v17
    v_perm_b32 v54, v37, v37, v18
    v_perm_b32 v55, v37, v37, v19
    s_waitcnt vmcnt(28)
    v_mfma_f32_16x16x16_bf16 v[8:11], v[48:49], v[96:97], v[8:11]
    v_mfma_f32_16x16x16_bf16 v[12:15], v[48:49], v[98:99], v[12:15]
    v_mfma_f32_16x16x16_bf16 v[8:11], v[50:51], v[100:101], v[8:11]
    v_mfma_f32_16x16x16_bf16 v[12:15], v[50:51], v[102:103], v[12:15]
    v_mfma_f32_16x16x16_bf16 v[8:11], v[52:53], v[104:105], v[8:11]
    v_mfma_f32_16x16x16_bf16 v[12:15], v[52:53], v[106:107], v[12:15]
    v_mfma_f32_16x16x16_bf16 v[8:11], v[54:55], v[108:109], v[8:11]
    v_mfma_f32_16x16x16_bf16 v[12:15], v[54:55], v[110:111], v[12:15]
    v_perm_b32 v56, v38, v38, v16
    v_perm_b32 v57, v38, v38, v17
    v_perm_b32 v58, v38, v38, v18
    v_perm_b32 v59, v38, v38, v19
    v_perm_b32 v60, v39, v39, v16
    v_perm_b32 v61, v39, v39, v17
    v_perm_b32 v62, v39, v39, v18
    v_perm_b32 v63, v39, v39, v19
    s_waitcnt vmcnt(22)
    v_mfma_f32_16x16x16_bf16 v[8:11], v[56:57], v[112:113], v[8:11]
    v_mfma_f32_16x16x16_bf16 v[12:15], v[56:57], v[114:115], v[12:15]
    v_mfma_f32_16x16x16_bf16 v[8:11], v[58:59], v[116:117], v[8:11]
    v_mfma_f32_16x16x16_bf16 v[12:15], v[58:59], v[118:119], v[12:15]
    v_mfma_f32_16x16x16_bf16 v[8:11], v[60:61], v[120:121], v[8:11]
    v_mfma_f32_16x16x16_bf16 v[12:15], v[60:61], v[122:123], v[12:15]
    v_mfma_f32_16x16x16_bf16 v[8:11], v[62:63], v[124:125], v[8:11]
    v_mfma_f32_16x16x16_bf16 v[12:15], v[62:63], v[126:127], v[12:15]
    v_perm_b32 v48, v40, v40, v16
    v_perm_b32 v49, v40, v40, v17
    v_perm_b32 v50, v40, v40, v18
    v_perm_b32 v51, v40, v40, v19
    v_perm_b32 v52, v41, v41, v16
    v_perm_b32 v53, v41, v41, v17
    v_perm_b32 v54, v41, v41, v18
    v_perm_b32 v55, v41, v41, v19
    s_waitcnt vmcnt(17)
    v_mfma_f32_16x16x16_bf16 v[8:11], v[48:49], v[128:129], v[8:11]
    v_mfma_f32_16x16x16_bf16 v[12:15], v[48:49], v[130:131], v[12:15]
    v_mfma_f32_16x16x16_bf16 v[8:11], v[50:51], v[132:133], v[8:11]
    v_mfma_f32_16x16x16_bf16 v[12:15], v[50:51], v[134:135], v[12:15]
    v_mfma_f32_16x16x16_bf16 v[8:11], v[52:53], v[136:137], v[8:11]
    v_mfma_f32_16x16x16_bf16 v[12:15], v[52:53], v[138:139], v[12:15]
    v_mfma_f32_16x16x16_bf16 v[8:11], v[54:55], v[140:141], v[8:11]
    v_mfma_f32_16x16x16_bf16 v[12:15], v[54:55], v[142:143], v[12:15]
    v_perm_b32 v56, v42, v42, v16
    v_perm_b32 v57, v42, v42, v17
    v_perm_b32 v58, v42, v42, v18
    v_perm_b32 v59, v42, v42, v19
    v_perm_b32 v60, v43, v43, v16
    v_perm_b32 v61, v43, v43, v17
    v_perm_b32 v62, v43, v43, v18
    v_perm_b32 v63, v43, v43, v19
    s_waitcnt vmcnt(11)
    v_mfma_f32_16x16x16_bf16 v[8:11], v[56:57], v[144:145], v[8:11]
    v_mfma_f32_16x16x16_bf16 v[12:15], v[56:57], v[146:147], v[12:15]
    v_mfma_f32_16x16x16_bf16 v[8:11], v[58:59], v[148:149], v[8:11]
    v_mfma_f32_16x16x16_bf16 v[12:15], v[58:59], v[150:151], v[12:15]
    v_mfma_f32_16x16x16_bf16 v[8:11], v[60:61], v[152:153], v[8:11]
    v_mfma_f32_16x16x16_bf16 v[12:15], v[60:61], v[154:155], v[12:15]
    v_mfma_f32_16x16x16_bf16 v[8:11], v[62:63], v[156:157], v[8:11]
    v_mfma_f32_16x16x16_bf16 v[12:15], v[62:63], v[158:159], v[12:15]
    v_perm_b32 v48, v44, v44, v16
    v_perm_b32 v49, v44, v44, v17
    v_perm_b32 v50, v44, v44, v18
    v_perm_b32 v51, v44, v44, v19
    v_perm_b32 v52, v45, v45, v16
    v_perm_b32 v53, v45, v45, v17
    v_perm_b32 v54, v45, v45, v18
    v_perm_b32 v55, v45, v45, v19
    s_waitcnt vmcnt(5)
    v_mfma_f32_16x16x16_bf16 v[8:11], v[48:49], v[160:161], v[8:11]
    v_mfma_f32_16x16x16_bf16 v[12:15], v[48:49], v[162:163], v[12:15]
    v_mfma_f32_16x16x16_bf16 v[8:11], v[50:51], v[164:165], v[8:11]
    v_mfma_f32_16x16x16_bf16 v[12:15], v[50:51], v[166:167], v[12:15]
    v_mfma_f32_16x16x16_bf16 v[8:11], v[52:53], v[168:169], v[8:11]
    v_mfma_f32_16x16x16_bf16 v[12:15], v[52:53], v[170:171], v[12:15]
    v_mfma_f32_16x16x16_bf16 v[8:11], v[54:55], v[172:173], v[8:11]
    v_mfma_f32_16x16x16_bf16 v[12:15], v[54:55], v[174:175], v[12:15]
    v_perm_b32 v56, v46, v46, v16
    v_perm_b32 v57, v46, v46, v17
    v_perm_b32 v58, v46, v46, v18
    v_perm_b32 v59, v46, v46, v19
    v_perm_b32 v60, v47, v47, v16
    v_perm_b32 v61, v47, v47, v17
    v_perm_b32 v62, v47, v47, v18
    v_perm_b32 v63, v47, v47, v19
    s_waitcnt vmcnt(4)
    v_mfma_f32_16x16x16_bf16 v[8:11], v[56:57], v[176:177], v[8:11]
    v_mfma_f32_16x16x16_bf16 v[12:15], v[56:57], v[178:179], v[12:15]
    s_waitcnt vmcnt(2)
    v_mfma_f32_16x16x16_bf16 v[8:11], v[58:59], v[180:181], v[8:11]
    v_mfma_f32_16x16x16_bf16 v[12:15], v[58:59], v[182:183], v[12:15]
    s_waitcnt vmcnt(1)
    v_mfma_f32_16x16x16_bf16 v[8:11], v[60:61], v[184:185], v[8:11]
    v_mfma_f32_16x16x16_bf16 v[12:15], v[60:61], v[186:187], v[12:15]
    s_waitcnt vmcnt(0)
    v_mfma_f32_16x16x16_bf16 v[8:11], v[62:63], v[188:189], v[8:11]
    v_mfma_f32_16x16x16_bf16 v[12:15], v[62:63], v[190:191], v[12:15]
    s_nop 6
    ds_write_b128 v4, v[8:11]
    ds_write_b128 v4, v[12:15] offset:16
    s_mov_b32 exec_lo, 0x1
    s_mov_b32 exec_hi, 0x0
    ds_add_u32 v20, v22 offset:48
    s_mov_b64 exec, -1
    s_setprio 0
L_vend:
    s_cmp_eq_u32 s29, 7
    s_cbranch_scc1 L_fin
    s_add_u32 m0, s57, 16384
    s_mov_b32 s62, 0
L_lw60:
    ds_read_b32 v24, v20 offset:52
    s_add_u32 s62, s62, 1
    s_waitcnt lgkmcnt(0)
    v_readfirstlane_b32 s76, v24
    s_nop 0
    s_cmp_ge_u32 s76, 4
    s_cbranch_scc1 L_lwd61
    s_sleep 1
    s_cmp_lt_u32 s62, 800000
    s_cbranch_scc1 L_lw60
L_lwd61:
    buffer_load_dwordx4 v26, s[40:43], s73 offen lds
    s_add_u32 m0, m0, 1024
    s_add_u32 s73, s73, 57344
    buffer_load_dwordx4 v26, s[40:43], s73 offen lds
    s_add_u32 m0, m0, 1024
    s_add_u32 s73, s73, 57344
    buffer_load_dwordx4 v26, s[40:43], s73 offen lds
    s_add_u32 m0, m0, 1024
    s_add_u32 s73, s73, 57344
    buffer_load_dwordx4 v26, s[40:43], s73 offen lds
    s_add_u32 m0, m0, 1024
    s_add_u32 s73, s73, 57344
    s_barrier
    s_mov_b32 s62, 0
L_lw62:
    ds_read_b32 v24, v20 offset:12
    s_add_u32 s62, s62, 1
    s_waitcnt lgkmcnt(0)
    v_readfirstlane_b32 s76, v24
    s_nop 0
    s_cmp_ge_u32 s76, 1
    s_cbranch_scc1 L_lwd63
    s_sleep 1
    s_cmp_lt_u32 s62, 800000
    s_cbranch_scc1 L_lw62
L_lwd63:
    buffer_load_dwordx4 v26, s[40:43], s73 offen lds
    s_add_u32 m0, m0, 1024
    s_add_u32 s73, s73, 57344
    buffer_load_dwordx4 v26, s[40:43], s73 offen lds
    s_add_u32 m0, m0, 1024
    s_add_u32 s73, s73, 57344
    buffer_load_dwordx4 v26, s[40:43], s73 offen lds
    s_add_u32 m0, m0, 1024
    s_add_u32 s73, s73, 57344
    buffer_load_dwordx4 v26, s[40:43], s73 offen lds
    s_add_u32 m0, m0, 1024
    s_add_u32 s73, s73, 57344
    s_mov_b32 exec_lo, 0x1
    s_mov_b32 exec_hi, 0x0
    ds_add_u32 v20, v22 offset:20
    s_mov_b64 exec, -1
    s_waitcnt vmcnt(0)
    s_mov_b32 exec_lo, 0x1
    s_mov_b32 exec_hi, 0x0
    ds_add_u32 v20, v22 offset:128
    s_mov_b64 exec, -1
    s_mov_b32 s62, 0
L_lw64:
    ds_read_b32 v24, v20 offset:4
    s_add_u32 s62, s62, 1
    s_waitcnt lgkmcnt(0)
    v_readfirstlane_b32 s76, v24
    s_nop 0
    s_cmp_ge_u32 s76, 4
    s_cbranch_scc1 L_lwd65
    s_sleep 1
    s_cmp_lt_u32 s62, 800000
    s_cbranch_scc1 L_lw64
L_lwd65:
    buffer_load_dwordx4 v27, s[44:47], s74 offen lds
    s_add_u32 m0, m0, 1024
    s_add_u32 s74, s74, 4096
    buffer_load_dwordx4 v27, s[44:47], s74 offen lds
    s_add_u32 m0, m0, 1024
    s_add_u32 s74, s74, 4096
    buffer_load_dwordx4 v28, s[44:47], s74 offen lds
    s_add_u32 m0, m0, 1024
    s_add_u32 s74, s74, 4096
    buffer_load_dwordx4 v28, s[44:47], s74 offen lds
    s_add_u32 m0, m0, 1024
    s_add_u32 s74, s74, 4096
    buffer_load_dwordx4 v27, s[44:47], s74 offen lds
    s_add_u32 m0, m0, 1024
    s_add_u32 s74, s74, 4096
    buffer_load_dwordx4 v27, s[44:47], s74 offen lds
    s_add_u32 m0, m0, 1024
    s_add_u32 s74, s74, 4096
    buffer_load_dwordx4 v28, s[44:47], s74 offen lds
    s_add_u32 m0, m0, 1024
    s_add_u32 s74, s74, 4096
    buffer_load_dwordx4 v28, s[44:47], s74 offen lds
    s_waitcnt vmcnt(0)
    s_barrier
L_fin:
L_end:
    s_endpgm
L_pl5:
    buffer_store_dwordx4 v[24:27], v121, s[48:51], s69 offen sc1
    s_branch L_pe6
L_pl22:
    buffer_store_dwordx4 v[96:99], v1, s[48:51], s74 offen sc1
    s_branch L_pe23
L_last:
.fill (1024 - ((L_last-sequential_preLN__sliding_block_cached__dense_activation_silu__decode_kernel) % 1024)) / 4, 4, 0xBF810000
L_codeend:
.section .rodata,"a"
.p2align 6
.amdhsa_kernel sequential_preLN__sliding_block_cached__dense_activation_silu__decode_kernel
.amdhsa_next_free_vgpr 256
.amdhsa_next_free_sgpr 102
.amdhsa_accum_offset 256
.amdhsa_group_segment_fixed_size 0
.amdhsa_kernarg_size 88
.amdhsa_user_sgpr_count 2
.amdhsa_user_sgpr_kernarg_segment_ptr 1
.amdhsa_system_sgpr_workgroup_id_x 1
.end_amdhsa_kernel
```
